```python
import torch

def _softmax(x, axis=-1):
    return torch.softmax(x, dim=axis)
def _gelu(x):
    return torch.nn.functional.gelu(x, approximate="tanh")
def _silu(x):
    return torch.nn.functional.silu(x)
def _sigmoid(x):
    return torch.sigmoid(x)
def _layernorm(x, axis=-1, eps=1e-5):
    m = x.mean(dim=axis, keepdim=True)
    v = x.var(dim=axis, keepdim=True, unbiased=False)
    return (x - m) / torch.sqrt(v + eps)
def _scatter_add(tgt, idx, src, axis=0):
    return tgt.clone().index_add_(axis, idx, src)
def _segment_sum(src, seg, n):
    out = torch.zeros((n,) + src.shape[1:], dtype=src.dtype)
    return out.index_add_(0, seg, src)
def _pad(x, pw):
    flat = tuple(v for pair in reversed(pw) for v in pair)
    return torch.nn.functional.pad(x, flat)

kernel_name = 'gated_mix__compressed_kv_cla__geglu_ffn__decode'

def setup_inputs():

    _w = (lambda a: (lambda t: t.to(torch.bfloat16) if t.is_floating_point() else t)(torch.as_tensor(a)))
    def _A_setup():
        B, H, Sq, Sk, D, M = 1, 32, 1, 16384, 128, 640
        Dc = 4 * D
        return {
            "x": _w((lambda *s: torch.randn(*s, dtype=torch.bfloat16) * 0.05)(B, Sq, M)),
            "c_kv": _w((lambda *s: torch.randn(*s, dtype=torch.bfloat16) * 0.8)(B, Sk, Dc)),
            "w_q": _w((lambda *s: torch.randn(*s, dtype=torch.bfloat16) * 6.4)(M, H, D) * (M ** -0.5)),
            "w_uk": _w((lambda *s: torch.randn(*s, dtype=torch.bfloat16) * 6.4)(Dc, H, D) * (Dc ** -0.5)),
            "w_uv": _w((lambda *s: torch.randn(*s, dtype=torch.bfloat16) * 0.8)(Dc, H, D) * (Dc ** -0.5)),
            "w_o": _w((lambda *s: torch.randn(*s, dtype=torch.bfloat16) * 0.8)(H, D, M) * ((H * D) ** -0.5)),
        }
    _A_in = _A_setup()

    def _B_setup():
        B, S, D, F = 1, 1, 640, 1728
        return {
            "x": _w((lambda *s: torch.randn(*s, dtype=torch.bfloat16) * 0.05)(B, S, D)),
            "w_gate": _w((lambda *s: torch.randn(*s, dtype=torch.bfloat16) * 0.1)(D, F)),
            "w_up": _w((lambda *s: torch.randn(*s, dtype=torch.bfloat16) * 0.1)(D, F)),
            "w_down": _w((lambda *s: torch.randn(*s, dtype=torch.bfloat16) * 0.1)(F, D)),
        }
    _B_in = _B_setup()

    return {
        "A_x": _A_in["x"],
        "A_c_kv": _A_in["c_kv"],
        "A_w_q": _A_in["w_q"],
        "A_w_uk": _A_in["w_uk"],
        "A_w_uv": _A_in["w_uv"],
        "A_w_o": _A_in["w_o"],
        "B_x": _B_in["x"],
        "B_w_gate": _B_in["w_gate"],
        "B_w_up": _B_in["w_up"],
        "B_w_down": _B_in["w_down"],
        "gate_w": _w((lambda *s: torch.randn(*s, dtype=torch.bfloat16) * 0.1)(640) * 16.0),
    }

def reference(A_x, A_c_kv, A_w_q, A_w_uk, A_w_uv, A_w_o, B_x, B_w_gate, B_w_up, B_w_down, gate_w):
    def _A_ref(x, c_kv, w_q, w_uk, w_uv, w_o):
        B, Sq, M = x.shape[0], x.shape[1], x.shape[2]
        Sk = c_kv.shape[1]
        H, D = w_q.shape[1], w_q.shape[2]
        q = torch.einsum("bqm,mhd->bhqd", x, w_q)
        k = torch.einsum("bkc,chd->bhkd", c_kv, w_uk)
        v = torch.einsum("bkc,chd->bhkd", c_kv, w_uv)
        scores = torch.einsum("bhqd,bhkd->bhqk", q, k) * (D ** -0.5)
        off = Sk - Sq
        qi = torch.arange(Sq)[:, None]
        kj = torch.arange(Sk)[None, :]
        cmask = kj <= (qi + off)
        scores = torch.where(cmask[None, None], scores, -1e9)
        p = _softmax(scores, axis=-1)
        ctx = torch.einsum("bhqk,bhkd->bhqd", p, v)
        return torch.einsum("bhqd,hdm->bqm", ctx, w_o)

    def _B_ref(x, w_gate, w_up, w_down):
        return (_gelu(x @ w_gate) * (x @ w_up)) @ w_down

    x = A_x
    g = _sigmoid((x * gate_w).sum(-1, keepdims=True))
    a = _A_ref(x, A_c_kv, A_w_q, A_w_uk, A_w_uv, A_w_o)
    b = _B_ref(x, B_w_gate, B_w_up, B_w_down)
    return g * a + (1 - g) * b
```

```asm
; @launch grid=(256,1,1) block=(512,1,1) lds=163840
.amdgcn_target "amdgcn-amd-amdhsa--gfx950"
.text
  .globl gated_mix__compressed_kv_cla__geglu_ffn__decode_kernel
  .p2align 8
  .type gated_mix__compressed_kv_cla__geglu_ffn__decode_kernel,@function
gated_mix__compressed_kv_cla__geglu_ffn__decode_kernel:
  s_load_dwordx8 s[64:71], s[0:1], 0
  s_load_dwordx2 s[16:17], s[0:1], 104
  v_cmp_gt_u32 vcc, 256, v0
  s_lshr_b32 s31, s2, 5
  s_and_b32 s30, s2, 31
  s_lshl_b32 s8, s30, 8
  v_lshlrev_b32 v1, 9, v0
  v_and_b32 v1, 0xffffe000, v1
  v_and_b32 v3, 15, v0
  v_lshl_or_b32 v1, v3, 4, v1
  s_cbranch_vccnz LO
  s_getpc_b64 s[26:27]
  v_and_b32 v254, 63, v0
  v_lshlrev_b32 v254, 7, v254
  global_load_dword v255, v254, s[26:27] offset:256
  s_cmp_ge_u32 s31, 4
  s_cbranch_scc1 ATT
  s_branch HI
LO:
  s_mul_i32 s9, s31, 655360
  s_add_u32 s9, s9, s8
  v_add_u32 v4, s9, v1
  s_mov_b32 s10, 0x20000
  s_cmp_ge_u32 s31, 8
  s_cbranch_scc1 END
  s_waitcnt lgkmcnt(0)
  global_load_dwordx4 v[120:123], v4, s[68:69] nt
  v_add_u32 v4, s10, v4
  global_load_dwordx4 v[124:127], v4, s[68:69] nt
  v_add_u32 v4, s10, v4
  global_load_dwordx4 v[128:131], v4, s[68:69] nt
  v_add_u32 v4, s10, v4
  global_load_dwordx4 v[132:135], v4, s[68:69] nt
  v_add_u32 v4, s10, v4
  global_load_dwordx4 v[136:139], v4, s[68:69] nt
  v_lshrrev_b32 v5, 6, v0
  v_bfe_u32 v7, v0, 4, 1
  v_lshlrev_b32 v7, 2, v7
  v_lshl_add_u32 v7, v5, 3, v7
  s_mul_i32 s11, s31, 160
  v_add_u32 v7, s11, v7
  v_bfe_u32 v6, v0, 5, 1
  v_lshl_add_u32 v6, v6, 5, v7
  global_load_dword v8, v6, s[64:65]
  global_load_dword v9, v6, s[64:65] offset:64
  global_load_dword v10, v7, s[64:65] offset:128
  s_load_dword s24, s[16:17], 0
  s_lshl_b32 s9, s30, 13
  s_add_u32 s9, s9, 1572864
  s_lshl_b32 s11, s31, 10
  s_add_u32 s11, s11, s9
  s_add_u32 s14, s11, 6291456
  v_lshrrev_b32 v6, 5, v0
  v_lshlrev_b32 v6, 7, v6
  v_add_u32 v6, s14, v6
  global_load_dword v31, v6, s[16:17] sc1
  s_load_dwordx16 s[40:55], s[0:1], 0
  s_load_dwordx8 s[56:63], s[0:1], 64
  v_readfirstlane_b32 s3, v5
  v_and_b32 v0, 63, v0
  v_lshrrev_b32 v2, 4, v0
  s_mov_b32 s18, 8388608
  s_mov_b32 s19, 0x20000
  s_and_b32 s33, s2, 127
  s_getpc_b64 s[26:27]
PFB:
  s_and_b32 s28, s2, 0xf8
  s_lshl_b32 s28, s28, 6
  s_sub_u32 s28, s28, PFB-gated_mix__compressed_kv_cla__geglu_ffn__decode_kernel
  s_lshl_b32 s29, s3, 7
  s_add_u32 s28, s28, s29
  s_ashr_i32 s29, s28, 31
  s_add_u32 s26, s26, s28
  s_addc_u32 s27, s27, s29
  s_load_dword s28, s[26:27], 0
  s_load_dword s29, s[26:27], 64
  v_and_b32 v25, 1, v3
  v_cmp_eq_u32 vcc, 1, v25
  v_mov_b32 v26, 0x0c0c0100
  v_mov_b32 v25, 0x01000c0c
  v_cndmask_b32 v26, v26, v25, vcc
  v_mov_b32 v27, 0x0c0c0302
  v_mov_b32 v25, 0x03020c0c
  v_cndmask_b32 v27, v27, v25, vcc
  v_bfe_u32 v25, v3, 2, 1
  v_cmp_eq_u32 vcc, 0, v25
  v_mov_b32 v20, 0x0c0c0c0c
  v_mov_b32 v22, 0x0c0c0c0c
  v_cndmask_b32 v20, v20, v26, vcc
  v_cndmask_b32 v22, v22, v27, vcc
  v_cmp_eq_u32 vcc, 1, v25
  v_mov_b32 v21, 0x0c0c0c0c
  v_mov_b32 v23, 0x0c0c0c0c
  v_cndmask_b32 v21, v21, v26, vcc
  v_cndmask_b32 v23, v23, v27, vcc
  v_and_b32 v25, 2, v3
  v_cmp_eq_u32 vcc, 2, v25
  v_mov_b32 v24, 0x4444
  v_mov_b32 v25, 0xeeee
  v_cndmask_b32 v24, v24, v25, vcc
  v_mov_b32 v140, 0
  v_mov_b32 v32, 0
  v_mov_b32 v141, 0
  v_mov_b32 v33, 0
  v_mov_b32 v142, 0
  v_mov_b32 v34, 0
  v_mov_b32 v143, 0
  v_mov_b32 v35, 0
  v_lshlrev_b32 v11, 5, v3
  v_lshl_add_u32 v11, v2, 4, v11
  s_lshl_b32 s12, s3, 9
  s_add_u32 s12, s12, 131072
  v_add_u32 v11, s12, v11
  v_lshlrev_b32 v5, 4, v0
  v_lshlrev_b32 v17, 2, v0
  v_lshlrev_b32 v18, 3, v0
  v_add_u32 v18, 131072, v18
  s_waitcnt vmcnt(8)
  s_barrier
  s_waitcnt lgkmcnt(0)
  s_add_u32 s24, s24, 1
  v_mov_b32 v37, s24
  v_mov_b32 v39, s24
  s_waitcnt vmcnt(0)
  v_perm_b32 v40, v8, v8, v20
  v_perm_b32 v41, v8, v8, v21
  v_perm_b32 v42, v8, v8, v22
  v_perm_b32 v43, v8, v8, v23
  v_perm_b32 v44, v9, v9, v20
  v_perm_b32 v45, v9, v9, v21
  v_perm_b32 v46, v9, v9, v22
  v_perm_b32 v47, v9, v9, v23
  v_perm_b32 v48, v10, v10, v20
  v_perm_b32 v49, v10, v10, v21
  v_perm_b32 v50, v10, v10, v22
  v_perm_b32 v51, v10, v10, v23
  s_nop 0
  v_smfmac_f32_16x16x64_bf16 v[32:35], v[40:43], v[120:127], v24
  v_smfmac_f32_16x16x64_bf16 v[32:35], v[44:47], v[128:135], v24
  v_smfmac_f32_16x16x64_bf16 v[32:35], v[48:51], v[136:143], v24
  s_nop 6
  s_mov_b32 exec_hi, 0
  ds_write_b128 v11, v[32:35]
  s_mov_b64 exec, -1
  s_waitcnt lgkmcnt(0)
  s_barrier
  s_cmp_lg_u32 s3, 0
  s_cbranch_scc1 Q_DONE
  ds_read_b64 v[60:61], v18 offset:0
  ds_read_b64 v[62:63], v18 offset:512
  ds_read_b64 v[64:65], v18 offset:1024
  ds_read_b64 v[66:67], v18 offset:1536
  s_waitcnt lgkmcnt(2)
  v_pk_add_f32 v[60:61], v[60:61], v[62:63]
  s_waitcnt lgkmcnt(0)
  v_pk_add_f32 v[64:65], v[64:65], v[66:67]
  v_add_f32 v36, v60, v64
  v_add_f32 v38, v61, v65
  buffer_store_dwordx4 v[36:39], v5, s[16:19], s14 offen
  buffer_store_dwordx4 v[36:39], v5, s[16:19], s11 offen sc1
Q_DONE:
  s_cmp_ge_u32 s31, 4
  s_cbranch_scc1 SIDE
  s_cmp_lg_u32 s3, 1
  s_cbranch_scc1 T_NOG
  v_lshrrev_b32 v12, 3, v0
  v_and_b32 v13, 7, v0
  v_lshlrev_b32 v14, 5, v13
  v_cmp_eq_u32 vcc, 2, v12
  v_lshlrev_b32 v15, 4, v12
  s_nop 0
  v_cndmask_b32 v15, v15, 12, vcc
  v_add_u32 v15, v15, v14
  v_cndmask_b32 v16, 4, 16, vcc
  v_add_u32 v16, v16, v15
  v_lshlrev_b32 v12, 14, v12
  v_lshl_add_u32 v12, v13, 4, v12
  s_lshl_b32 s10, s30, 9
  s_lshl_b32 s12, s31, 7
  s_add_u32 s10, s10, s12
  s_add_u32 s10, s10, 262144
  v_mov_b32 v55, s24
  s_mov_b32 s25, 200000
  s_add_u32 s12, s9, 6291456
T_QP:
  s_add_u32 s13, s12, 4096
  buffer_load_dwordx4 v[60:63], v5, s[16:19], s12 offen offset:0 sc1
  buffer_load_dwordx4 v[64:67], v5, s[16:19], s12 offen offset:1024 sc1
  buffer_load_dwordx4 v[68:71], v5, s[16:19], s12 offen offset:2048 sc1
  buffer_load_dwordx4 v[72:75], v5, s[16:19], s12 offen offset:3072 sc1
  buffer_load_dwordx4 v[76:79], v5, s[16:19], s13 offen offset:0 sc1
  buffer_load_dwordx4 v[80:83], v5, s[16:19], s13 offen offset:1024 sc1
  buffer_load_dwordx4 v[84:87], v5, s[16:19], s13 offen offset:2048 sc1
  buffer_load_dwordx4 v[88:91], v5, s[16:19], s13 offen offset:3072 sc1
  s_waitcnt vmcnt(7)
  v_xor_b32 v31, s24, v61
  v_bitop3_b32 v31, v63, s24, v31 bitop3:0xbe
  s_waitcnt vmcnt(6)
  v_bitop3_b32 v31, v65, s24, v31 bitop3:0xbe
  v_bitop3_b32 v31, v67, s24, v31 bitop3:0xbe
  v_add_f32 v60, v60, v64
  v_add_f32 v62, v62, v66
  s_waitcnt vmcnt(5)
  v_bitop3_b32 v31, v69, s24, v31 bitop3:0xbe
  v_bitop3_b32 v31, v71, s24, v31 bitop3:0xbe
  s_waitcnt vmcnt(4)
  v_bitop3_b32 v31, v73, s24, v31 bitop3:0xbe
  v_bitop3_b32 v31, v75, s24, v31 bitop3:0xbe
  v_add_f32 v68, v68, v72
  v_add_f32 v70, v70, v74
  s_waitcnt vmcnt(3)
  v_bitop3_b32 v31, v77, s24, v31 bitop3:0xbe
  v_bitop3_b32 v31, v79, s24, v31 bitop3:0xbe
  s_waitcnt vmcnt(2)
  v_bitop3_b32 v31, v81, s24, v31 bitop3:0xbe
  v_bitop3_b32 v31, v83, s24, v31 bitop3:0xbe
  v_add_f32 v76, v76, v80
  v_add_f32 v78, v78, v82
  s_waitcnt vmcnt(1)
  v_bitop3_b32 v31, v85, s24, v31 bitop3:0xbe
  v_bitop3_b32 v31, v87, s24, v31 bitop3:0xbe
  s_waitcnt vmcnt(0)
  v_bitop3_b32 v31, v89, s24, v31 bitop3:0xbe
  v_bitop3_b32 v31, v91, s24, v31 bitop3:0xbe
  v_add_f32 v84, v84, v88
  v_add_f32 v86, v86, v90
  v_cmp_ne_u32 vcc, 0, v31
  s_cbranch_vccz T_QP_OK
  s_sub_u32 s25, s25, 1
  s_cmp_gt_u32 s25, 199994
  s_cbranch_scc1 T_QP
  s_and_b32 s12, s25, 1
  s_cselect_b32 s12, 0, 6291456
  s_add_u32 s12, s12, s9
  s_cmp_lg_u32 s25, 0
  s_cbranch_scc1 T_QP
T_QP_OK:
  v_add_f32 v60, v60, v68
  v_add_f32 v62, v62, v70
  v_add_f32 v76, v76, v84
  v_add_f32 v78, v78, v86
  v_add_f32 v60, v60, v76
  v_add_f32 v62, v62, v78
  v_cvt_pk_bf16_f32 v60, v60, v62
  ds_write_b32 v17, v60 offset:35072
  s_waitcnt lgkmcnt(0)
  s_barrier
  s_barrier
  ds_read_b32 v52, v15 offset:35328
  ds_read_b32 v53, v16 offset:35328
  ds_read_b32 v54, v15 offset:35336
  s_mov_b64 exec, 0xffffff
  s_waitcnt lgkmcnt(0)
  buffer_store_dwordx4 v[52:55], v12, s[16:19], s10 offen sc1
  s_mov_b64 exec, -1
  s_branch T_LO
T_NOG:
  s_barrier
  s_barrier
T_LO:
  s_mov_b32 s4, s48
  s_mov_b32 s5, s49
  s_mov_b32 s6, 4194304
  s_mov_b32 s7, 0x20000
  v_lshlrev_b32 v4, 1, v2
  v_xor_b32 v4, v4, v3
  v_lshlrev_b32 v4, 4, v4
  v_lshl_add_u32 v4, v2, 17, v4
  v_xor_b32 v5, 0x80, v4
  s_lshl_b32 s12, s31, 5
  s_add_u32 s12, s12, s3
  s_lshl_b32 s12, s12, 15
  s_lshl_b32 s13, s30, 8
  s_add_u32 s12, s12, s13
  s_lshl_b32 s15, s3, 13
  s_cmp_eq_u32 s3, 0
  s_cbranch_scc1 T_TRK
  s_barrier
  s_barrier
T_TRK:
  s_add_u32 m0, s15, 0
  s_add_u32 s14, s12, 0
  buffer_load_dwordx4 v4, s[4:7], s14 offen nt lds
  s_cmp_lg_u32 s3, 0
  s_cbranch_scc1 TRK_1
  s_waitcnt vmcnt(0)
TRK_1:
  s_add_u32 m0, s15, 1024
  s_add_u32 s14, s12, 524288
  buffer_load_dwordx4 v4, s[4:7], s14 offen nt lds
  s_cmp_lg_u32 s3, 0
  s_cbranch_scc1 TRK_2
  s_waitcnt vmcnt(0)
  s_barrier
  s_barrier
TRK_2:
  s_add_u32 m0, s15, 2048
  s_add_u32 s14, s12, 8192
  buffer_load_dwordx4 v5, s[4:7], s14 offen nt lds
  s_add_u32 m0, s15, 3072
  s_add_u32 s14, s12, 532480
  buffer_load_dwordx4 v5, s[4:7], s14 offen nt lds
  s_add_u32 m0, s15, 4096
  s_add_u32 s14, s12, 16384
  buffer_load_dwordx4 v4, s[4:7], s14 offen nt lds
  s_add_u32 m0, s15, 5120
  s_add_u32 s14, s12, 540672
  buffer_load_dwordx4 v4, s[4:7], s14 offen nt lds
  s_add_u32 m0, s15, 6144
  s_add_u32 s14, s12, 24576
  s_waitcnt vmcnt(5)
  buffer_load_dwordx4 v5, s[4:7], s14 offen nt lds
  s_add_u32 m0, s15, 7168
  s_add_u32 s14, s12, 548864
  s_waitcnt vmcnt(5)
  buffer_load_dwordx4 v5, s[4:7], s14 offen nt lds
  s_branch T_WO
  .p2align 7
HI:
  s_lshl_b32 s9, s31, 20
  s_add_u32 s9, s9, s8
  s_sub_u32 s9, s9, 0x20000
  v_add_u32 v19, s9, v1
  s_mov_b32 s10, 0x20000
  s_waitcnt lgkmcnt(0)
  s_barrier
  global_load_dwordx4 v[200:203], v19, s[70:71] nt
  v_add_u32 v19, s10, v19
  global_load_dwordx4 v[204:207], v19, s[70:71] nt
  v_add_u32 v19, s10, v19
  global_load_dwordx4 v[208:211], v19, s[70:71] nt
  v_add_u32 v19, s10, v19
  global_load_dwordx4 v[212:215], v19, s[70:71] nt
  v_add_u32 v19, s10, v19
  global_load_dwordx4 v[216:219], v19, s[70:71] nt
  v_add_u32 v19, s10, v19
  global_load_dwordx4 v[220:223], v19, s[70:71] nt
  v_add_u32 v19, s10, v19
  global_load_dwordx4 v[224:227], v19, s[70:71] nt
  v_add_u32 v19, s10, v19
  global_load_dwordx4 v[228:231], v19, s[70:71] nt
  s_barrier
  s_load_dword s24, s[16:17], 0
  s_load_dwordx16 s[40:55], s[0:1], 0
  s_load_dwordx8 s[56:63], s[0:1], 64
  v_lshrrev_b32 v5, 6, v0
  v_and_b32 v0, 63, v0
  v_lshrrev_b32 v2, 4, v0
  v_readfirstlane_b32 s3, v5
  s_mov_b32 s18, 8388608
  s_mov_b32 s19, 0x20000
  s_and_b32 s33, s2, 127
  v_and_b32 v25, 1, v3
  v_cmp_eq_u32 vcc, 1, v25
  v_mov_b32 v26, 0x0c0c0100
  v_mov_b32 v25, 0x01000c0c
  v_cndmask_b32 v26, v26, v25, vcc
  v_mov_b32 v27, 0x0c0c0302
  v_mov_b32 v25, 0x03020c0c
  v_cndmask_b32 v27, v27, v25, vcc
  v_bfe_u32 v25, v3, 2, 1
  v_cmp_eq_u32 vcc, 0, v25
  v_mov_b32 v20, 0x0c0c0c0c
  v_mov_b32 v22, 0x0c0c0c0c
  v_cndmask_b32 v20, v20, v26, vcc
  v_cndmask_b32 v22, v22, v27, vcc
  v_cmp_eq_u32 vcc, 1, v25
  v_mov_b32 v21, 0x0c0c0c0c
  v_mov_b32 v23, 0x0c0c0c0c
  v_cndmask_b32 v21, v21, v26, vcc
  v_cndmask_b32 v23, v23, v27, vcc
  v_and_b32 v25, 2, v3
  v_cmp_eq_u32 vcc, 2, v25
  v_mov_b32 v24, 0x4444
  v_mov_b32 v25, 0xeeee
  v_cndmask_b32 v24, v24, v25, vcc
  v_lshrrev_b32 v6, 3, v3
  v_bfe_u32 v7, v3, 2, 1
  v_lshl_add_u32 v6, v7, 1, v6
  v_bfe_u32 v7, v3, 1, 1
  v_lshl_add_u32 v6, v7, 2, v6
  v_lshl_add_u32 v6, v6, 4, v2
  s_lshl_b32 s9, s3, 2
  s_sub_u32 s9, s9, 16
  v_add_u32 v6, s9, v6
  v_lshlrev_b32 v6, 1, v6
  v_cmp_ne_u32 vcc, 0, v7
  v_lshlrev_b32 v7, 4, v3
  v_mov_b32 v56, 0
  v_mov_b32 v57, 0
  v_mov_b32 v58, 0
  v_mov_b32 v59, 0
  v_mov_b32 v60, 0
  v_mov_b32 v61, 0
  v_mov_b32 v62, 0
  v_mov_b32 v63, 0
  s_waitcnt lgkmcnt(0)
  s_add_u32 s24, s24, 1
  s_waitcnt vmcnt(0)
  s_barrier
  ds_read_b128 v[32:35], v7 offset:35072
  s_waitcnt lgkmcnt(0)
  v_dot2c_f32_bf16 v56, v200, v32
  v_dot2c_f32_bf16 v57, v204, v32
  v_dot2c_f32_bf16 v58, v208, v32
  v_dot2c_f32_bf16 v59, v212, v32
  v_dot2c_f32_bf16 v60, v216, v32
  v_dot2c_f32_bf16 v61, v220, v32
  v_dot2c_f32_bf16 v62, v224, v32
  v_dot2c_f32_bf16 v63, v228, v32
  v_dot2c_f32_bf16 v56, v201, v33
  v_dot2c_f32_bf16 v57, v205, v33
  v_dot2c_f32_bf16 v58, v209, v33
  v_dot2c_f32_bf16 v59, v213, v33
  v_dot2c_f32_bf16 v60, v217, v33
  v_dot2c_f32_bf16 v61, v221, v33
  v_dot2c_f32_bf16 v62, v225, v33
  v_dot2c_f32_bf16 v63, v229, v33
  v_dot2c_f32_bf16 v56, v202, v34
  v_dot2c_f32_bf16 v57, v206, v34
  v_dot2c_f32_bf16 v58, v210, v34
  v_dot2c_f32_bf16 v59, v214, v34
  v_dot2c_f32_bf16 v60, v218, v34
  v_dot2c_f32_bf16 v61, v222, v34
  v_dot2c_f32_bf16 v62, v226, v34
  v_dot2c_f32_bf16 v63, v230, v34
  v_dot2c_f32_bf16 v56, v203, v35
  v_dot2c_f32_bf16 v57, v207, v35
  v_dot2c_f32_bf16 v58, v211, v35
  v_dot2c_f32_bf16 v59, v215, v35
  v_dot2c_f32_bf16 v60, v219, v35
  v_dot2c_f32_bf16 v61, v223, v35
  v_dot2c_f32_bf16 v62, v227, v35
  v_dot2c_f32_bf16 v63, v231, v35
  v_add_f32_dpp v56, v56, v56 row_ror:8 row_mask:0xf bank_mask:0x3
  v_add_f32_dpp v58, v58, v58 row_ror:8 row_mask:0xf bank_mask:0x3
  v_add_f32_dpp v60, v60, v60 row_ror:8 row_mask:0xf bank_mask:0x3
  v_add_f32_dpp v62, v62, v62 row_ror:8 row_mask:0xf bank_mask:0x3
  v_add_f32_dpp v56, v57, v57 row_ror:8 row_mask:0xf bank_mask:0xc
  v_add_f32_dpp v58, v59, v59 row_ror:8 row_mask:0xf bank_mask:0xc
  v_add_f32_dpp v60, v61, v61 row_ror:8 row_mask:0xf bank_mask:0xc
  v_add_f32_dpp v62, v63, v63 row_ror:8 row_mask:0xf bank_mask:0xc
  v_add_f32_dpp v56, v56, v56 row_half_mirror row_mask:0xf bank_mask:0x5
  v_add_f32_dpp v60, v60, v60 row_half_mirror row_mask:0xf bank_mask:0x5
  v_add_f32_dpp v56, v58, v58 row_half_mirror row_mask:0xf bank_mask:0xa
  v_add_f32_dpp v60, v62, v62 row_half_mirror row_mask:0xf bank_mask:0xa
  s_nop 0
  v_add_f32_dpp v56, v56, v56 quad_perm:[2,3,0,1] row_mask:0xf bank_mask:0xf
  v_add_f32_dpp v60, v60, v60 quad_perm:[2,3,0,1] row_mask:0xf bank_mask:0xf
  v_cndmask_b32 v56, v56, v60, vcc
  s_nop 1
  v_add_f32_dpp v56, v56, v56 quad_perm:[1,0,3,2] row_mask:0xf bank_mask:0xf
  v_mul_f32 v56, 0x3e0293ee, v56
  v_cvt_pk_bf16_f32 v56, v56, v56
  ds_write_b16 v6, v56 offset:35328
  s_waitcnt lgkmcnt(0)
  s_barrier
  s_mov_b32 s20, s40
  s_mov_b32 s21, s41
  s_mov_b32 s22, 1280
  s_mov_b32 s23, 0x20000
  s_and_b32 s34, s33, 7
  s_lshr_b32 s35, s33, 5
  s_lshl3_add_u32 s34, s35, s34
  s_bfe_u32 s35, s33, 0x20003
  s_lshl2_add_u32 s34, s34, s35
  v_lshrrev_b32 v4, 3, v0
  v_and_b32 v8, 7, v0
  v_and_b32 v5, 1, v4
  v_lshrrev_b32 v6, 5, v0
  v_lshl_add_u32 v5, v6, 1, v5
  v_mul_u32_u24 v5, 20, v5
  v_bfe_u32 v6, v4, 1, 1
  v_add_u32 v5, v5, v6
  v_mul_u32_u24 v5, 3456, v5
  v_lshl_add_u32 v9, v8, 4, v5
  v_mul_u32_u24 v10, 40, v4
  s_cmp_lt_u32 s3, 6
  s_cselect_b32 s4, s54, s56
  s_cselect_b32 s5, s55, s57
  s_cselect_b32 s37, 0, 4096
  s_mov_b32 s6, 2211840
  s_mov_b32 s7, 0x20000
  s_and_b32 s11, s34, 3
  s_lshr_b32 s12, s34, 2
  s_and_b32 s26, s3, 1
  s_mul_i32 s13, s11, 552960
  s_lshl_b32 s14, s12, 7
  s_add_u32 s13, s13, s14
  s_mul_i32 s14, s26, 34560
  s_add_u32 s13, s13, s14
  s_add_u32 s14, s13, 276480
  s_mul_i32 s15, s11, 320
  s_mul_i32 s27, s26, 20
  s_add_u32 s15, s15, s27
  s_lshl_b32 s12, s12, 13
  s_add_u32 s12, s12, 1310720
  s_lshl_b32 s27, s11, 10
  s_lshl_b32 s26, s26, 9
  s_add_u32 s37, s37, s12
  s_add_u32 s37, s37, s27
  s_add_u32 s37, s37, s26
  s_add_u32 s36, s37, 6291456
  s_lshl_b32 s11, s11, 7
  s_add_u32 s38, s12, s11
  v_and_b32 v11, 1, v2
  v_lshrrev_b32 v12, 1, v2
  v_lshl_add_u32 v11, v11, 1, v12
  v_lshl_add_u32 v11, v8, 2, v11
  v_lshlrev_b32 v11, 4, v11
  v_lshlrev_b32 v12, 10, v4
  v_lshl_add_u32 v12, v8, 4, v12
  v_lshlrev_b32 v13, 7, v2
  v_lshlrev_b32 v14, 2, v8
  v_mov_b32 v32, 0
  v_mov_b32 v33, 0
  v_mov_b32 v34, 0
  v_mov_b32 v35, 0
  v_mov_b32 v37, s24
  v_mov_b32 v39, s24
  s_lshl_b32 s28, s33, 7
  s_add_u32 s28, s28, 196608
  s_add_u32 s29, s28, 6291456
  buffer_load_dword v31, off, s[16:19], s29 sc1
  s_barrier
  s_cmp_lt_u32 s34, 108
  s_cbranch_scc1 T_FFN
  s_barrier
  s_branch T_G
T_FFN:
  buffer_load_dword v31, v13, s[16:19], s36 offen sc1
  buffer_load_dwordx4 v[160:163], v10, s[20:23], s15 offen
  buffer_load_dword v164, v10, s[20:23], s15 offen offset:16
  buffer_load_dwordx4 v[120:123], v9, s[4:7], s13 offen nt
  s_add_u32 s13, s13, 6912
  buffer_load_dwordx4 v[124:127], v9, s[4:7], s14 offen nt
  s_add_u32 s14, s14, 6912
  buffer_load_dwordx4 v[128:131], v9, s[4:7], s13 offen nt
  s_add_u32 s13, s13, 6912
  buffer_load_dwordx4 v[132:135], v9, s[4:7], s14 offen nt
  s_add_u32 s14, s14, 6912
  buffer_load_dwordx4 v[136:139], v9, s[4:7], s13 offen nt
  s_add_u32 s13, s13, 6912
  buffer_load_dwordx4 v[140:143], v9, s[4:7], s14 offen nt
  s_add_u32 s14, s14, 6912
  buffer_load_dwordx4 v[144:147], v9, s[4:7], s13 offen nt
  s_add_u32 s13, s13, 6912
  buffer_load_dwordx4 v[148:151], v9, s[4:7], s14 offen nt
  s_add_u32 s14, s14, 6912
  buffer_load_dwordx4 v[152:155], v9, s[4:7], s13 offen nt
  buffer_load_dwordx4 v[156:159], v9, s[4:7], s14 offen nt
  s_barrier
  s_waitcnt vmcnt(10)
  v_perm_b32 v40, v160, v160, v20
  v_perm_b32 v41, v160, v160, v21
  v_perm_b32 v42, v160, v160, v22
  v_perm_b32 v43, v160, v160, v23
  v_perm_b32 v44, v161, v161, v20
  v_perm_b32 v45, v161, v161, v21
  v_perm_b32 v46, v161, v161, v22
  v_perm_b32 v47, v161, v161, v23
  v_perm_b32 v48, v162, v162, v20
  v_perm_b32 v49, v162, v162, v21
  v_perm_b32 v50, v162, v162, v22
  v_perm_b32 v51, v162, v162, v23
  v_perm_b32 v52, v163, v163, v20
  v_perm_b32 v53, v163, v163, v21
  v_perm_b32 v54, v163, v163, v22
  v_perm_b32 v55, v163, v163, v23
  v_perm_b32 v56, v164, v164, v20
  v_perm_b32 v57, v164, v164, v21
  v_perm_b32 v58, v164, v164, v22
  v_perm_b32 v59, v164, v164, v23
  s_waitcnt vmcnt(8)
  v_smfmac_f32_16x16x64_bf16 v[32:35], v[40:43], v[120:127], v24
  s_waitcnt vmcnt(6)
  v_smfmac_f32_16x16x64_bf16 v[32:35], v[44:47], v[128:135], v24
  s_waitcnt vmcnt(4)
  v_smfmac_f32_16x16x64_bf16 v[32:35], v[48:51], v[136:143], v24
  s_waitcnt vmcnt(2)
  v_smfmac_f32_16x16x64_bf16 v[32:35], v[52:55], v[144:151], v24
  s_waitcnt vmcnt(0)
  v_smfmac_f32_16x16x64_bf16 v[32:35], v[56:59], v[152:159], v24
  s_nop 7
  v_permlane32_swap_b32 v32, v34
  v_permlane32_swap_b32 v33, v35
  s_nop 1
  v_add_f32_dpp v36, v34, v32 row_ror:8 row_mask:0xf bank_mask:0xf
  v_add_f32_dpp v38, v35, v33 row_ror:8 row_mask:0xf bank_mask:0xf
  s_mov_b32 exec_lo, 0x00ff00ff
  s_mov_b32 exec_hi, 0x00ff00ff
  buffer_store_dwordx4 v[36:39], v11, s[16:19], s36 offen
  s_mov_b64 exec, -1
  s_cmp_lg_u32 s3, 7
  s_cbranch_scc1 T_GB
  s_mov_b32 s25, 200000
  s_add_u32 s13, s38, 6291456
T_GP:
  buffer_load_dwordx4 v[40:43], v12, s[16:19], s13 offen sc1
  buffer_load_dwordx4 v[44:47], v12, s[16:19], s13 offen offset:512 sc1
  s_waitcnt vmcnt(0)
  v_xor_b32 v31, s24, v41
  v_bitop3_b32 v31, v43, s24, v31 bitop3:0xbe
  v_bitop3_b32 v31, v45, s24, v31 bitop3:0xbe
  v_bitop3_b32 v31, v47, s24, v31 bitop3:0xbe
  v_cmp_ne_u32 vcc, 0, v31
  s_cbranch_vccz T_GP_OK
  s_sub_u32 s25, s25, 1
  s_cmp_gt_u32 s25, 199994
  s_cbranch_scc1 T_GP
  s_cmp_lg_u32 s25, 199994
  s_cbranch_scc1 T_GP_NB
  s_mov_b32 exec_lo, 0x00ff00ff
  s_mov_b32 exec_hi, 0x00ff00ff
  buffer_store_dwordx4 v[36:39], v11, s[16:19], s37 offen sc1
  s_mov_b64 exec, -1
T_GP_NB:
  s_and_b32 s13, s25, 1
  s_cselect_b32 s13, 0, 6291456
  s_add_u32 s13, s13, s38
  s_cmp_lg_u32 s25, 0
  s_cbranch_scc1 T_GP
T_GP_OK:
  v_add_f32 v40, v40, v44
  v_add_f32 v42, v42, v46
  s_nop 1
  v_add_f32_dpp v40, v40, v40 row_ror:8 row_mask:0xf bank_mask:0xf
  v_add_f32_dpp v42, v42, v42 row_ror:8 row_mask:0xf bank_mask:0xf
  v_mov_b32 v41, v40
  v_mov_b32 v43, v42
  s_nop 1
  v_permlane16_swap_b32 v40, v41
  v_permlane16_swap_b32 v42, v43
  v_add_f32 v40, v40, v41
  v_add_f32 v42, v42, v43
  v_mov_b32 v41, v40
  v_mov_b32 v43, v42
  s_nop 1
  v_permlane32_swap_b32 v40, v41
  v_permlane32_swap_b32 v42, v43
  v_cvt_pk_bf16_f32 v40, v40, v40
  v_lshlrev_b32 v40, 16, v40
  v_cvt_pk_bf16_f32 v41, v41, v41
  v_lshlrev_b32 v41, 16, v41
  v_cvt_pk_bf16_f32 v42, v42, v42
  v_lshlrev_b32 v42, 16, v42
  v_cvt_pk_bf16_f32 v43, v43, v43
  v_lshlrev_b32 v43, 16, v43
  v_mul_f32 v44, v40, v40
  v_mul_f32 v44, 0x3d372713, v44
  v_add_f32 v44, 1.0, v44
  v_mul_f32 v44, v44, v40
  v_mul_f32 v44, 0xc0135761, v44
  v_exp_f32 v44, v44
  s_nop 0
  v_add_f32 v44, 1.0, v44
  v_rcp_f32 v44, v44
  s_nop 0
  v_mul_f32 v40, v40, v44
  v_cvt_pk_bf16_f32 v40, v40, v40
  v_lshlrev_b32 v40, 16, v40
  v_mul_f32 v40, v40, v41
  v_mul_f32 v44, v42, v42
  v_mul_f32 v44, 0x3d372713, v44
  v_add_f32 v44, 1.0, v44
  v_mul_f32 v44, v44, v42
  v_mul_f32 v44, 0xc0135761, v44
  v_exp_f32 v44, v44
  s_nop 0
  v_add_f32 v44, 1.0, v44
  v_rcp_f32 v44, v44
  s_nop 0
  v_mul_f32 v42, v42, v44
  v_cvt_pk_bf16_f32 v42, v42, v42
  v_lshlrev_b32 v42, 16, v42
  v_mul_f32 v42, v42, v43
  v_cvt_pk_bf16_f32 v48, v40, v42
  v_mov_b32 v49, s24
  v_mov_b32 v51, s24
  v_lshlrev_b32 v5, 4, v0
  v_mov_b32_dpp v50, v48 row_ror:4 row_mask:0xf bank_mask:0xf
  s_mov_b64 exec, 15
  buffer_store_dwordx4 v[48:51], v5, s[16:19], s29 offen
  buffer_store_dwordx4 v[48:51], v5, s[16:19], s28 offen sc1
  s_mov_b64 exec, -1
T_GB:
  s_mov_b32 exec_lo, 0x00ff00ff
  s_mov_b32 exec_hi, 0x00ff00ff
  buffer_store_dwordx4 v[36:39], v11, s[16:19], s37 offen sc1
  s_mov_b64 exec, -1
T_G:
  s_cmp_lg_u32 s3, 6
  s_cbranch_scc1 T_WO
  s_mov_b32 s8, s60
  s_mov_b32 s9, s61
  s_mov_b32 s10, 1280
  s_mov_b32 s11, 0x20000
  s_mov_b32 s20, s40
  s_mov_b32 s21, s41
  s_mov_b32 s22, 1280
  s_mov_b32 s23, 0x20000
  v_mul_u32_u24 v5, 20, v0
  buffer_load_dwordx4 v[40:43], v5, s[20:23], 0 offen
  buffer_load_dword v44, v5, s[20:23], 0 offen offset:16
  buffer_load_dwordx4 v[48:51], v5, s[8:11], 0 offen
  buffer_load_dword v52, v5, s[8:11], 0 offen offset:16
  v_mov_b32 v30, 0
  s_waitcnt vmcnt(0)
  v_lshlrev_b32 v56, 16, v40
  v_and_b32 v57, 0xffff0000, v40
  v_lshlrev_b32 v58, 16, v48
  v_and_b32 v59, 0xffff0000, v48
  v_pk_mul_f32 v[56:57], v[56:57], v[58:59]
  v_cvt_pk_bf16_f32 v56, v56, v57
  v_lshlrev_b32 v57, 16, v56
  v_and_b32 v56, 0xffff0000, v56
  v_add_f32 v30, v30, v57
  v_add_f32 v30, v30, v56
  v_lshlrev_b32 v56, 16, v41
  v_and_b32 v57, 0xffff0000, v41
  v_lshlrev_b32 v58, 16, v49
  v_and_b32 v59, 0xffff0000, v49
  v_pk_mul_f32 v[56:57], v[56:57], v[58:59]
  v_cvt_pk_bf16_f32 v56, v56, v57
  v_lshlrev_b32 v57, 16, v56
  v_and_b32 v56, 0xffff0000, v56
  v_add_f32 v30, v30, v57
  v_add_f32 v30, v30, v56
  v_lshlrev_b32 v56, 16, v42
  v_and_b32 v57, 0xffff0000, v42
  v_lshlrev_b32 v58, 16, v50
  v_and_b32 v59, 0xffff0000, v50
  v_pk_mul_f32 v[56:57], v[56:57], v[58:59]
  v_cvt_pk_bf16_f32 v56, v56, v57
  v_lshlrev_b32 v57, 16, v56
  v_and_b32 v56, 0xffff0000, v56
  v_add_f32 v30, v30, v57
  v_add_f32 v30, v30, v56
  v_lshlrev_b32 v56, 16, v43
  v_and_b32 v57, 0xffff0000, v43
  v_lshlrev_b32 v58, 16, v51
  v_and_b32 v59, 0xffff0000, v51
  v_pk_mul_f32 v[56:57], v[56:57], v[58:59]
  v_cvt_pk_bf16_f32 v56, v56, v57
  v_lshlrev_b32 v57, 16, v56
  v_and_b32 v56, 0xffff0000, v56
  v_add_f32 v30, v30, v57
  v_add_f32 v30, v30, v56
  v_lshlrev_b32 v56, 16, v44
  v_and_b32 v57, 0xffff0000, v44
  v_lshlrev_b32 v58, 16, v52
  v_and_b32 v59, 0xffff0000, v52
  v_pk_mul_f32 v[56:57], v[56:57], v[58:59]
  v_cvt_pk_bf16_f32 v56, v56, v57
  v_lshlrev_b32 v57, 16, v56
  v_and_b32 v56, 0xffff0000, v56
  v_add_f32 v30, v30, v57
  v_add_f32 v30, v30, v56
  v_mov_b32 v31, v30
  s_nop 1
  v_permlane32_swap_b32 v30, v31
  v_add_f32 v30, v30, v31
  v_mov_b32 v31, v30
  s_nop 1
  v_permlane16_swap_b32 v30, v31
  v_add_f32 v30, v30, v31
  s_nop 1
  v_add_f32_dpp v30, v30, v30 row_ror:8 row_mask:0xf bank_mask:0xf
  s_nop 1
  v_add_f32_dpp v30, v30, v30 row_ror:4 row_mask:0xf bank_mask:0xf
  s_nop 1
  v_add_f32_dpp v30, v30, v30 row_ror:2 row_mask:0xf bank_mask:0xf
  s_nop 1
  v_add_f32_dpp v30, v30, v30 row_ror:1 row_mask:0xf bank_mask:0xf
  v_cvt_pk_bf16_f32 v30, v30, v30
  v_lshlrev_b32 v30, 16, v30
  v_mul_f32 v30, 0xbfb8aa3b, v30
  v_exp_f32 v30, v30
  s_nop 0
  v_add_f32 v30, 1.0, v30
  v_rcp_f32 v30, v30
  s_nop 0
  v_cvt_pk_bf16_f32 v30, v30, v30
  v_lshlrev_b32 v30, 16, v30
  v_sub_f32 v31, 1.0, v30
  v_cvt_pk_bf16_f32 v31, v31, v31
  v_lshlrev_b32 v31, 16, v31
  v_mov_b32 v32, 0
  v_mov_b32 v33, s24
  s_mov_b64 exec, 1
  buffer_store_dwordx4 v[30:33], off, s[16:19], s29 offset:64
  buffer_store_dwordx4 v[30:33], off, s[16:19], s28 offset:64 sc1
  s_mov_b64 exec, -1
T_WO:
  s_and_b32 s34, s33, 7
  s_lshr_b32 s35, s33, 5
  s_lshl3_add_u32 s34, s35, s34
  s_bfe_u32 s35, s33, 0x20003
  s_lshl2_add_u32 s34, s34, s35
  s_lshl_b32 s39, s30, 2
  s_add_u32 s39, s39, s31
  s_lshl_b32 s35, s39, 10
  s_lshl_b32 s14, s3, 7
  s_add_u32 s35, s35, s14
  s_add_u32 s35, s35, 4096
  s_add_u32 s36, s35, 6291456
  v_mov_b32 v11, 0
  buffer_load_dword v31, v11, s[16:19], s36 offen sc1
  v_bfe_u32 v5, v0, 1, 1
  v_lshlrev_b32 v5, 3, v5
  v_lshl_add_u32 v5, v2, 1, v5
  v_and_b32 v6, 1, v0
  v_add_u32 v5, v5, v6
  v_lshlrev_b32 v5, 11, v5
  s_lshl_b32 s13, s3, 15
  s_lshl_b32 s14, s31, 6
  s_add_u32 s13, s13, s14
  s_and_b32 s14, s30, 7
  s_lshl_b32 s14, s14, 8
  s_add_u32 s13, s13, s14
  s_lshr_b32 s14, s30, 3
  s_lshl_b32 s14, s14, 4
  s_add_u32 s13, s13, s14
  s_add_u32 s13, s13, 327680
  s_lshl_b32 s12, s39, 3
  s_add_u32 s12, s12, s3
  s_lshl_b32 s12, s12, 12
  s_add_u32 s12, s12, 2097152
  v_lshlrev_b32 v10, 4, v0
  s_lshl_b32 s14, s3, 2
  s_add_u32 s14, s14, 35584
  v_mov_b32 v6, s14
  v_lshlrev_b32 v7, 4, v3
  v_lshl_add_u32 v7, v2, 3, v7
  s_mul_i32 s14, s3, 272
  v_add_u32 v7, s14, v7
  v_and_b32 v8, 7, v0
  v_mul_u32_u24 v8, 272, v8
  v_lshl_add_u32 v8, v2, 4, v8
  v_bfe_u32 v12, v0, 2, 2
  v_lshl_add_u32 v12, v2, 3, v12
  v_lshlrev_b32 v12, 8, v12
  v_and_b32 v13, 3, v0
  v_lshl_add_u32 v12, v13, 3, v12
  s_lshl_b32 s14, s3, 5
  v_add_u32 v12, s14, v12
  v_bfe_u32 v14, v0, 2, 3
  v_lshlrev_b32 v14, 5, v14
  v_xor_b32 v12, v12, v14
  v_lshlrev_b32 v14, 3, v3
  v_add_u32 v16, s24, v3
  s_mov_b32 s14, 0x9e3779b1
  v_mul_lo_u32 v16, v16, s14
  v_lshrrev_b32 v17, 3, v3
  v_lshrrev_b32 v18, 1, v2
  v_lshl_add_u32 v17, v17, 1, v18
  v_lshlrev_b32 v17, 4, v17
  v_bfe_u32 v18, v3, 2, 1
  v_lshl_add_u32 v17, v18, 1, v17
  v_and_b32 v18, 1, v2
  v_add_u32 v17, v17, v18
  v_lshlrev_b32 v17, 2, v17
  v_lshlrev_b32 v18, 4, v18
  v_add_u32 v18, 35584, v18
  v_xor_b32 v13, 16, v18
  v_lshlrev_b32 v4, 4, v2
  v_mov_b32 v65, s24
  v_mov_b32 v67, s24
  v_mov_b32 v71, s24
  v_not_b32 v35, s24
  s_cmp_lg_u32 s3, 5
  s_cbranch_scc1 T_BW
  v_lshlrev_b32 v9, 10, v3
  s_and_b32 s27, s33, 7
  s_lshl_b32 s27, s27, 7
  s_add_u32 s27, s27, 6520832
  s_mov_b32 s25, 80
  s_mov_b64 exec, 0xffff
T_LH:
  buffer_load_dword v79, v9, s[16:19], s27 offen sc1
  s_waitcnt vmcnt(0)
  v_cmp_ne_u32 vcc, s24, v79
  s_bcnt1_i32_b64 s14, vcc
  s_cmp_le_u32 s14, 2
  s_cbranch_scc1 T_LH2
  s_sleep 1
  s_sub_u32 s25, s25, 1
  s_cmp_lg_u32 s25, 0
  s_cbranch_scc1 T_LH
T_LH2:
  s_mov_b64 exec, -1
T_BW:
  s_waitcnt vmcnt(0)
  s_barrier
  s_mov_b32 s25, 200000
  buffer_load_dwordx4 v[32:35], v5, s[16:19], s13 offen sc1
  buffer_load_dwordx4 v[80:83], v10, s[16:19], s12 offen offset:0 sc1
  buffer_load_dwordx4 v[84:87], v10, s[16:19], s12 offen offset:1024 sc1
  buffer_load_dwordx4 v[88:91], v10, s[16:19], s12 offen offset:2048 sc1
  buffer_load_dwordx4 v[92:95], v10, s[16:19], s12 offen offset:3072 sc1
  ds_read_b64_tr_b16 v[100:101], v12 offset:0
  ds_read_b64_tr_b16 v[102:103], v12 offset:1024
  ds_read_b64_tr_b16 v[104:105], v12 offset:8192
  ds_read_b64_tr_b16 v[106:107], v12 offset:9216
  ds_read_b64_tr_b16 v[108:109], v12 offset:16384
  ds_read_b64_tr_b16 v[110:111], v12 offset:17408
  ds_read_b64_tr_b16 v[112:113], v12 offset:24576
  ds_read_b64_tr_b16 v[114:115], v12 offset:25600
  s_branch T_CH
T_PB:
  s_mov_b32 s25, 200000
T_ALL:
  s_mov_b64 s[28:29], -1
T_RL:
  s_cbranch_vccz T_NS
  s_mov_b64 exec, vcc
  buffer_load_dwordx4 v[32:35], v5, s[16:19], s13 offen sc1
  s_mov_b64 exec, -1
T_NS:
  s_and_b32 s14, s28, 0x33333333
  s_cbranch_scc0 T_NL0
  buffer_load_dwordx4 v[80:83], v10, s[16:19], s12 offen offset:0 sc1
T_NL0:
  s_and_b32 s14, s29, 0x33333333
  s_cbranch_scc0 T_NL1
  buffer_load_dwordx4 v[84:87], v10, s[16:19], s12 offen offset:1024 sc1
T_NL1:
  s_and_b32 s14, s28, 0xcccccccc
  s_cbranch_scc0 T_NL2
  buffer_load_dwordx4 v[88:91], v10, s[16:19], s12 offen offset:2048 sc1
T_NL2:
  s_and_b32 s14, s29, 0xcccccccc
  s_cbranch_scc0 T_NL3
  buffer_load_dwordx4 v[92:95], v10, s[16:19], s12 offen offset:3072 sc1
T_NL3:
  s_sub_u32 s25, s25, 1
T_CH:
  s_waitcnt vmcnt(0)
T_CH2:
  v_cmp_ne_u32 vcc, s24, v35
  s_cbranch_vccz T_VER
  s_mov_b64 s[28:29], vcc
  s_cmp_gt_i32 s25, 0
  s_cbranch_scc1 T_RL
T_VER:
  ds_bpermute_b32 v30, v17, v34
  v_mov_b32 v76, v32
  v_add3_u32 v72, v80, v81, v82
  v_add3_u32 v73, v84, v85, v86
  v_add3_u32 v74, v88, v89, v90
  v_add3_u32 v75, v92, v93, v94
  v_max_f32_dpp v76, v76, v76 quad_perm:[1,0,3,2] row_mask:0xf bank_mask:0xf
  v_add_u32 v72, v72, v83
  v_add_u32 v73, v73, v87
  v_add_u32 v74, v74, v91
  v_add_u32 v75, v75, v95
  v_max_f32_dpp v76, v76, v76 quad_perm:[2,3,0,1] row_mask:0xf bank_mask:0xf
  v_add_u32_dpp v72, v72, v72 row_ror:8 row_mask:0xf bank_mask:0x3
  v_mov_b32 v77, v76
  v_add_u32_dpp v74, v74, v74 row_ror:8 row_mask:0xf bank_mask:0x3
  v_add_u32_dpp v72, v73, v73 row_ror:8 row_mask:0xf bank_mask:0xc
  v_permlane16_swap_b32 v76, v77
  v_add_u32_dpp v74, v75, v75 row_ror:8 row_mask:0xf bank_mask:0xc
  v_max_f32 v76, v76, v77
  v_mov_b32 v77, v76
  v_add_u32_dpp v72, v72, v72 row_half_mirror row_mask:0xf bank_mask:0x5
  v_add_u32_dpp v72, v74, v74 row_half_mirror row_mask:0xf bank_mask:0xa
  v_permlane32_swap_b32 v76, v77
  v_max_f32 v76, v76, v77
  v_add_u32_dpp v72, v72, v72 quad_perm:[1,0,3,2] row_mask:0xf bank_mask:0xf
  v_sub_f32 v36, v32, v76
  v_exp_f32 v36, v36
  v_add_u32_dpp v72, v72, v72 quad_perm:[2,3,0,1] row_mask:0xf bank_mask:0xf
  s_waitcnt lgkmcnt(0)
  v_cmp_ne_u32 vcc, v72, v30
  s_cbranch_vccz T_OK
  s_mov_b64 vcc, 0
  s_cmp_gt_i32 s25, 0
  s_cbranch_scc1 T_ALL
T_OK:
  v_mov_b32_dpp v40, v36 quad_perm:[0,0,0,0] row_mask:0xf bank_mask:0xf
  v_mov_b32_dpp v41, v36 quad_perm:[1,1,1,1] row_mask:0xf bank_mask:0xf
  v_mov_b32_dpp v42, v36 quad_perm:[2,2,2,2] row_mask:0xf bank_mask:0xf
  v_mov_b32_dpp v43, v36 quad_perm:[3,3,3,3] row_mask:0xf bank_mask:0xf
  v_cvt_pk_bf16_f32 v28, v40, v41
  v_cvt_pk_bf16_f32 v29, v42, v43
  v_mul_f32 v77, v36, v33
  v_mov_b32 v56, 0
  v_mov_b32 v57, 0
  v_mov_b32 v58, 0
  v_mov_b32 v59, 0
  v_xor_b32 v80, v16, v80
  v_xor_b32 v81, v16, v81
  v_xor_b32 v82, v16, v82
  v_xor_b32 v83, v16, v83
  v_xor_b32 v84, v16, v84
  v_xor_b32 v85, v16, v85
  v_xor_b32 v86, v16, v86
  v_xor_b32 v87, v16, v87
  v_perm_b32 v44, v28, v28, v20
  v_perm_b32 v45, v28, v28, v21
  v_perm_b32 v46, v28, v28, v22
  v_perm_b32 v47, v28, v28, v23
  v_perm_b32 v48, v29, v29, v20
  v_perm_b32 v49, v29, v29, v21
  v_perm_b32 v50, v29, v29, v22
  v_perm_b32 v51, v29, v29, v23
  v_smfmac_f32_16x16x64_bf16 v[56:59], v[44:47], v[80:87], v24
  v_xor_b32 v88, v16, v88
  v_xor_b32 v89, v16, v89
  v_xor_b32 v90, v16, v90
  v_xor_b32 v91, v16, v91
  v_xor_b32 v92, v16, v92
  v_xor_b32 v93, v16, v93
  v_xor_b32 v94, v16, v94
  v_xor_b32 v95, v16, v95
  v_add_f32_dpp v77, v77, v77 quad_perm:[1,0,3,2] row_mask:0xf bank_mask:0xf
  s_nop 0
  v_smfmac_f32_16x16x64_bf16 v[56:59], v[48:51], v[88:95], v24
  v_add_f32_dpp v77, v77, v77 quad_perm:[2,3,0,1] row_mask:0xf bank_mask:0xf
  v_mov_b32 v78, v77
  s_nop 1
  v_permlane16_swap_b32 v77, v78
  v_add_f32 v77, v77, v78
  v_mov_b32 v78, v77
  s_nop 1
  v_permlane32_swap_b32 v77, v78
  v_add_f32 v77, v77, v78
  v_cvt_pk_bf16_f32 v56, v56, v57
  v_cvt_pk_bf16_f32 v57, v58, v59
  s_mov_b32 exec_hi, 0
  ds_write_b64 v7, v[56:57] offset:32768
  s_mov_b64 exec, -1
  ds_write2_b32 v6, v76, v77 offset0:0 offset1:8
  s_waitcnt lgkmcnt(0)
  s_barrier
  ds_read_b128 v[80:83], v8 offset:32768
  ds_read_b128 v[84:87], v8 offset:32832
  ds_read_b128 v[88:91], v8 offset:32896
  ds_read_b128 v[92:95], v8 offset:32960
  ds_read_b128 v[36:39], v18
  ds_read_b128 v[40:43], v13
  ds_read_b128 v[44:47], v18 offset:32
  s_waitcnt lgkmcnt(6)
  v_mfma_f32_16x16x32_bf16 v[52:55], v[80:83], v[100:103], 0
  s_waitcnt lgkmcnt(5)
  v_mfma_f32_16x16x32_bf16 v[52:55], v[84:87], v[104:107], v[52:55]
  s_waitcnt lgkmcnt(4)
  v_mfma_f32_16x16x32_bf16 v[52:55], v[88:91], v[108:111], v[52:55]
  s_waitcnt lgkmcnt(3)
  v_mfma_f32_16x16x32_bf16 v[52:55], v[92:95], v[112:115], v[52:55]
  s_waitcnt lgkmcnt(1)
  v_max3_f32 v40, v40, v41, v42
  v_max3_f32 v41, v36, v37, v38
  v_max3_f32 v40, v40, v43, v39
  v_max_f32 v40, v40, v41
  v_sub_f32 v36, v36, v40
  v_sub_f32 v37, v37, v40
  v_sub_f32 v38, v38, v40
  v_sub_f32 v39, v39, v40
  v_exp_f32 v36, v36
  v_exp_f32 v37, v37
  v_exp_f32 v38, v38
  v_exp_f32 v39, v39
  s_waitcnt lgkmcnt(0)
  v_mul_f32 v52, v52, v36
  v_mul_f32 v44, v44, v36
  v_fmac_f32 v52, v53, v37
  v_fmac_f32 v44, v45, v37
  v_fmac_f32 v52, v54, v38
  v_fmac_f32 v44, v46, v38
  v_fmac_f32 v52, v55, v39
  v_fmac_f32 v44, v47, v39
  v_mov_b32 v53, v52
  v_mov_b32 v45, v44
  s_nop 0
  v_permlane16_swap_b32 v52, v53
  v_permlane16_swap_b32 v44, v45
  v_add_f32 v64, v52, v53
  v_add_f32 v36, v44, v45
  v_rcp_f32 v36, v36
  s_nop 0
  v_mul_f32 v64, v64, v36
  s_nop 1
  v_mov_b32_dpp v66, v64 quad_perm:[1,0,3,2] row_mask:0xf bank_mask:0xf
  s_mov_b64 exec, 0x5555
  buffer_store_dwordx4 v[64:67], v14, s[16:19], s36 offen
  buffer_store_dwordx4 v[64:67], v14, s[16:19], s35 offen sc1
  s_mov_b64 exec, -1
  s_cmp_lg_u32 s3, 0
  s_cbranch_scc1 T_END
  s_cmp_lt_u32 s34, 80
  s_cbranch_scc1 T_FIN
T_END:
  s_endpgm
T_FIN:
  v_lshrrev_b32 v3, 5, v0
  s_mov_b32 s12, s62
  s_mov_b32 s13, s63
  s_mov_b32 s14, 1280
  s_mov_b32 s15, 0x20000
  s_mov_b32 s70, 0x0504000c
  s_mov_b32 s71, 0x0706010c
  s_mov_b32 s72, 0x0504020c
  s_mov_b32 s73, 0x0706030c
  v_and_b32 v7, 1, v0
  v_bfe_u32 v6, v0, 4, 1
  v_lshl_add_u32 v6, v6, 1, v3
  v_lshl_add_u32 v8, v7, 2, v6
  v_lshlrev_b32 v8, 1, v8
  s_lshl_b32 s27, s34, 4
  v_lshrrev_b32 v6, 1, v0
  v_mul_u32_u24 v6, 2560, v6
  v_lshl_add_u32 v6, v7, 4, v6
  s_lshl_b32 s4, s34, 5
  s_add_u32 s4, s4, 589824
  s_add_u32 s5, s4, 81920
  s_add_u32 s6, s4, 163840
  s_add_u32 s7, s4, 245760
  v_not_b32 v43, s24
  v_mov_b32 v47, v43
  v_mov_b32 v51, v43
  v_mov_b32 v55, v43
  s_mov_b32 s25, 200000
  s_and_b32 s10, s33, 31
  s_lshl_b32 s10, s10, 1
  s_lshl_b64 exec, 3, s10
F_PRE:
  buffer_load_dwordx4 v[40:43], v6, s[16:19], s4 offen sc1
  s_waitcnt vmcnt(0)
  v_cmp_ne_u32 vcc, s24, v43
  s_cbranch_vccz F_PRE2
  s_sleep 4
  s_sub_u32 s25, s25, 1
  s_cmp_lg_u32 s25, 0
  s_cbranch_scc1 F_PRE
F_PRE2:
  s_mov_b64 exec, -1
  s_mov_b32 s25, 200000
F_POLL:
  v_cmp_ne_u32 vcc, s24, v43
  s_cbranch_vccz F_SK0
  s_mov_b64 exec, vcc
  buffer_load_dwordx4 v[40:43], v6, s[16:19], s4 offen sc1
  s_mov_b64 exec, -1
F_SK0:
  v_cmp_ne_u32 vcc, s24, v47
  s_cbranch_vccz F_SK1
  s_mov_b64 exec, vcc
  buffer_load_dwordx4 v[44:47], v6, s[16:19], s5 offen sc1
  s_mov_b64 exec, -1
F_SK1:
  v_cmp_ne_u32 vcc, s24, v51
  s_cbranch_vccz F_SK2
  s_mov_b64 exec, vcc
  buffer_load_dwordx4 v[48:51], v6, s[16:19], s6 offen sc1
  s_mov_b64 exec, -1
F_SK2:
  v_cmp_ne_u32 vcc, s24, v55
  s_cbranch_vccz F_SK3
  s_mov_b64 exec, vcc
  buffer_load_dwordx4 v[52:55], v6, s[16:19], s7 offen sc1
  s_mov_b64 exec, -1
F_SK3:
  s_waitcnt vmcnt(0)
  v_xor_b32 v38, s24, v43
  v_bitop3_b32 v38, v47, s24, v38 bitop3:0xbe
  v_bitop3_b32 v38, v51, s24, v38 bitop3:0xbe
  v_bitop3_b32 v38, v55, s24, v38 bitop3:0xbe
  v_cmp_ne_u32 vcc, 0, v38
  s_cbranch_vccz F_OK
  s_sub_u32 s25, s25, 1
  s_cmp_lg_u32 s25, 0
  s_cbranch_scc1 F_POLL
F_OK:
  v_perm_b32 v60, v40, v42, s70
  v_perm_b32 v61, v40, v42, s71
  v_perm_b32 v62, v41, v42, s72
  v_perm_b32 v63, v41, v42, s73
  v_perm_b32 v64, v44, v46, s70
  v_perm_b32 v65, v44, v46, s71
  v_perm_b32 v66, v45, v46, s72
  v_perm_b32 v67, v45, v46, s73
  v_perm_b32 v68, v48, v50, s70
  v_perm_b32 v69, v48, v50, s71
  v_perm_b32 v70, v49, v50, s72
  v_perm_b32 v71, v49, v50, s73
  v_perm_b32 v72, v52, v54, s70
  v_perm_b32 v73, v52, v54, s71
  v_perm_b32 v74, v53, v54, s72
  v_perm_b32 v75, v53, v54, s73
  v_pk_add_f32 v[60:61], v[60:61], v[68:69]
  v_pk_add_f32 v[62:63], v[62:63], v[70:71]
  v_pk_add_f32 v[64:65], v[64:65], v[72:73]
  v_pk_add_f32 v[66:67], v[66:67], v[74:75]
  v_pk_add_f32 v[60:61], v[60:61], v[64:65]
  v_pk_add_f32 v[62:63], v[62:63], v[66:67]
  s_nop 1
  v_permlane32_swap_b32 v60, v61
  v_permlane32_swap_b32 v62, v63
  v_add_f32 v60, v60, v61
  v_add_f32 v62, v62, v63
  s_nop 1
  v_permlane16_swap_b32 v60, v62
  v_add_f32 v32, v60, v62
  s_nop 1
  v_add_f32_dpp v32, v32, v32 row_ror:8 row_mask:0xf bank_mask:0xf
  s_nop 1
  v_add_f32_dpp v32, v32, v32 row_ror:4 row_mask:0xf bank_mask:0xf
  s_nop 1
  v_add_f32_dpp v32, v32, v32 row_ror:2 row_mask:0xf bank_mask:0xf
  v_cvt_pk_bf16_f32 v32, v32, v32
  s_mov_b32 exec_lo, 0x00030003
  s_mov_b32 exec_hi, 0x00030003
  buffer_store_short v32, v8, s[12:15], s27 offen
  s_cmp_lg_u32 s33, 0
  s_cbranch_scc1 F_NOE
  s_mov_b64 exec, 1
  v_mov_b32 v5, 0
  v_mov_b32 v6, s24
  buffer_store_dword v6, v5, s[16:19], 0 offen
F_NOE:
  s_mov_b64 exec, -1
  s_endpgm
  .p2align 7
ATT:
  s_cmp_ge_u32 s31, 8
  s_cbranch_scc1 END
  v_lshrrev_b32 v1, 6, v0
  v_and_b32 v0, 63, v0
  s_lshl_b32 s8, s2, 2
  v_readfirstlane_b32 s3, v1
  v_lshlrev_b32 v62, 4, v0
  s_mov_b32 s10, 0
  s_sub_u32 s36, s3, 4
  s_add_u32 s8, s8, s36
  s_lshl_b32 s9, s36, 15
  s_bitset0_b32 s8, 9
  s_lshl_b32 s8, s8, 10
  s_mov_b32 m0, s9
  s_waitcnt lgkmcnt(0)
  s_add_u32 s66, s66, s8
  s_addc_u32 s67, s67, 0
  s_barrier
DMA0:
  s_lshl_b32 s11, s10, 5
  s_and_b32 s12, s10, 8
  s_and_b32 s11, s11, 0xe0
  s_lshl1_add_u32 s11, s12, s11
  v_xor_b32 v63, s11, v62
  s_waitcnt vmcnt(6)
  s_cmp_lg_u32 s10, 3
  s_cbranch_scc1 DMA0_NB
  s_barrier
DMA0_NB:
  global_load_lds_dwordx4 v63, s[66:67] nt
  v_add_u32 v62, 524288, v62
  s_add_u32 m0, m0, 0x400
  s_add_u32 s10, s10, 1
  s_cmp_lt_u32 s10, 10
  s_cbranch_scc1 DMA0
  s_load_dwordx16 s[40:55], s[0:1], 0
  s_load_dwordx8 s[56:63], s[0:1], 64
  s_load_dword s24, s[16:17], 0
  s_mov_b32 s18, 8388608
  s_mov_b32 s19, 0x20000
  s_and_b32 s33, s2, 127
  v_and_b32 v2, 31, v0
  v_lshrrev_b32 v3, 5, v0
  v_and_b32 v4, 7, v2
  v_bfe_u32 v5, v2, 3, 1
  v_lshl_add_u32 v4, v4, 1, v5
  v_xor_b32 v4, v4, v3
  v_lshlrev_b32 v4, 4, v4
  v_lshl_add_u32 v4, v2, 10, v4
  v_add_u32 v8, s9, v4
  v_xor_b32 v9, 32, v8
  v_xor_b32 v10, 64, v8
  v_xor_b32 v11, 96, v8
  v_xor_b32 v12, 128, v8
  v_xor_b32 v13, 160, v8
  v_xor_b32 v14, 192, v8
  v_xor_b32 v15, 224, v8
  v_xor_b32 v16, 0, v0
  v_lshlrev_b32 v16, 4, v16
  v_add_u32 v16, 131072, v16
  v_xor_b32 v17, 1, v0
  v_lshlrev_b32 v17, 4, v17
  v_add_u32 v17, 132096, v17
  v_xor_b32 v18, 2, v0
  v_lshlrev_b32 v18, 4, v18
  v_add_u32 v18, 133120, v18
  v_xor_b32 v19, 3, v0
  v_lshlrev_b32 v19, 4, v19
  v_add_u32 v19, 134144, v19
  v_xor_b32 v20, 4, v0
  v_lshlrev_b32 v20, 4, v20
  v_add_u32 v20, 135168, v20
  v_xor_b32 v21, 5, v0
  v_lshlrev_b32 v21, 4, v21
  v_add_u32 v21, 136192, v21
  v_xor_b32 v22, 6, v0
  v_lshlrev_b32 v22, 4, v22
  v_add_u32 v22, 137216, v22
  v_xor_b32 v23, 7, v0
  v_lshlrev_b32 v23, 4, v23
  v_add_u32 v23, 138240, v23
  v_lshlrev_b32 v6, 4, v2
  v_add_u32 v28, 139264, v6
  s_lshl_b32 s11, s36, 2
  v_add_u32 v29, s11, v28
  v_lshlrev_b32 v6, 5, v2
  v_add_u32 v31, 140288, v6
  v_lshl_add_u32 v31, v3, 2, v31
  s_lshl_b32 s11, s36, 3
  v_add_u32 v31, s11, v31
  s_lshl_b32 s11, s36, 11
  s_add_u32 s11, s11, 131072
  v_lshlrev_b32 v32, 4, v0
  v_add_u32 v32, s11, v32
  s_and_b32 s34, s33, 7
  s_lshr_b32 s35, s33, 5
  s_lshl3_add_u32 s34, s35, s34
  s_bfe_u32 s35, s33, 0x20003
  s_lshl2_add_u32 s34, s34, s35
  s_waitcnt lgkmcnt(0)
  s_add_u32 s24, s24, 1
  s_mov_b32 s4, s58
  s_mov_b32 s5, s59
  s_mov_b32 s6, 2211840
  s_mov_b32 s7, 0x20000
  s_mov_b32 s72, s50
  s_mov_b32 s73, s51
  s_mov_b32 s74, 5242880
  s_mov_b32 s75, 0x20000
  v_lshrrev_b32 v33, 4, v0
  v_and_b32 v34, 15, v0
  v_mul_u32_u24 v30, 1280, v33
  v_lshl_add_u32 v30, v34, 4, v30
  s_and_b32 s31, s31, 3
  s_lshl_b32 s39, s30, 2
  s_add_u32 s39, s39, s31
  s_lshl_b32 s14, s36, 8
  s_mul_i32 s26, s34, 20480
  s_add_u32 s26, s26, s14
  s_mul_i32 s27, s39, 40960
  s_add_u32 s27, s27, s14
DMA2:
  s_lshl_b32 s11, s10, 5
  s_and_b32 s12, s10, 8
  s_and_b32 s11, s11, 0xe0
  s_lshl1_add_u32 s11, s12, s11
  v_xor_b32 v63, s11, v62
  s_waitcnt vmcnt(6)
  global_load_lds_dwordx4 v63, s[66:67] nt
  v_add_u32 v62, 524288, v62
  s_add_u32 m0, m0, 0x400
  s_add_u32 s10, s10, 1
  s_cmp_lt_u32 s10, 32
  s_cbranch_scc1 DMA2
  s_barrier
  s_waitcnt vmcnt(0)
  ds_read_b128 v[128:131], v8 offset:0
  ds_read_b128 v[132:135], v9 offset:0
  ds_read_b128 v[136:139], v10 offset:0
  ds_read_b128 v[140:143], v11 offset:0
  ds_read_b128 v[144:147], v12 offset:0
  ds_read_b128 v[148:151], v13 offset:0
  ds_read_b128 v[152:155], v14 offset:0
  ds_read_b128 v[156:159], v15 offset:0
  ds_read_b128 v[160:163], v8 offset:256
  ds_read_b128 v[164:167], v9 offset:256
  ds_read_b128 v[168:171], v10 offset:256
  ds_read_b128 v[172:175], v11 offset:256
  ds_read_b128 v[176:179], v12 offset:256
  ds_read_b128 v[180:183], v13 offset:256
  ds_read_b128 v[184:187], v14 offset:256
  ds_read_b128 v[188:191], v15 offset:256
  ds_read_b128 v[192:195], v8 offset:512
  ds_read_b128 v[196:199], v9 offset:512
  ds_read_b128 v[200:203], v10 offset:512
  ds_read_b128 v[204:207], v11 offset:512
  ds_read_b128 v[208:211], v12 offset:512
  ds_read_b128 v[212:215], v13 offset:512
  ds_read_b128 v[216:219], v14 offset:512
  ds_read_b128 v[220:223], v15 offset:512
  ds_read_b128 v[224:227], v8 offset:768
  ds_read_b128 v[228:231], v9 offset:768
  ds_read_b128 v[232:235], v10 offset:768
  ds_read_b128 v[236:239], v11 offset:768
  ds_read_b128 v[240:243], v12 offset:768
  ds_read_b128 v[244:247], v13 offset:768
  ds_read_b128 v[248:251], v14 offset:768
  ds_read_b128 v[252:255], v15 offset:768
  buffer_load_dwordx4 v[80:83], v30, s[72:75], s27 offen nt
  s_add_u32 s27, s27, 5120
  buffer_load_dwordx4 v[84:87], v30, s[72:75], s27 offen nt
  s_add_u32 s27, s27, 5120
  buffer_load_dwordx4 v[88:91], v30, s[72:75], s27 offen nt
  s_add_u32 s27, s27, 5120
  buffer_load_dwordx4 v[92:95], v30, s[72:75], s27 offen nt
  s_add_u32 s27, s27, 5120
  s_setprio 2
  s_waitcnt lgkmcnt(0)
  s_barrier
  ds_read_b128 v[64:67], v16
  ds_read_b128 v[68:71], v17
  ds_read_b128 v[72:75], v18
  ds_read_b128 v[76:79], v19
  s_waitcnt lgkmcnt(3)
  v_mfma_f32_32x32x16_bf16 v[40:55], v[128:131], v[64:67], 0
  ds_read_b128 v[64:67], v20 offset:0
  s_waitcnt lgkmcnt(3)
  v_mfma_f32_32x32x16_bf16 v[40:55], v[132:135], v[68:71], v[40:55]
  ds_read_b128 v[68:71], v21 offset:0
  s_waitcnt lgkmcnt(3)
  v_mfma_f32_32x32x16_bf16 v[40:55], v[136:139], v[72:75], v[40:55]
  ds_read_b128 v[72:75], v22 offset:0
  buffer_load_dwordx4 v[96:99], v30, s[72:75], s27 offen nt
  s_add_u32 s27, s27, 5120
  s_waitcnt lgkmcnt(3)
  v_mfma_f32_32x32x16_bf16 v[40:55], v[140:143], v[76:79], v[40:55]
  ds_read_b128 v[76:79], v23 offset:0
  s_waitcnt lgkmcnt(3)
  v_mfma_f32_32x32x16_bf16 v[40:55], v[144:147], v[64:67], v[40:55]
  ds_read_b128 v[64:67], v16 offset:8192
  s_waitcnt lgkmcnt(3)
  v_mfma_f32_32x32x16_bf16 v[40:55], v[148:151], v[68:71], v[40:55]
  ds_read_b128 v[68:71], v17 offset:8192
  buffer_load_dwordx4 v[100:103], v30, s[72:75], s27 offen nt
  s_add_u32 s27, s27, 5120
  s_waitcnt lgkmcnt(3)
  v_mfma_f32_32x32x16_bf16 v[40:55], v[152:155], v[72:75], v[40:55]
  ds_read_b128 v[72:75], v18 offset:8192
  s_waitcnt lgkmcnt(3)
  v_mfma_f32_32x32x16_bf16 v[40:55], v[156:159], v[76:79], v[40:55]
  ds_read_b128 v[76:79], v19 offset:8192
  s_waitcnt lgkmcnt(3)
  v_mfma_f32_32x32x16_bf16 v[40:55], v[160:163], v[64:67], v[40:55]
  ds_read_b128 v[64:67], v20 offset:8192
  s_waitcnt lgkmcnt(3)
  v_mfma_f32_32x32x16_bf16 v[40:55], v[164:167], v[68:71], v[40:55]
  ds_read_b128 v[68:71], v21 offset:8192
  s_waitcnt lgkmcnt(3)
  v_mfma_f32_32x32x16_bf16 v[40:55], v[168:171], v[72:75], v[40:55]
  ds_read_b128 v[72:75], v22 offset:8192
  s_waitcnt lgkmcnt(3)
  v_mfma_f32_32x32x16_bf16 v[40:55], v[172:175], v[76:79], v[40:55]
  ds_read_b128 v[76:79], v23 offset:8192
  s_waitcnt lgkmcnt(3)
  v_mfma_f32_32x32x16_bf16 v[40:55], v[176:179], v[64:67], v[40:55]
  ds_read_b128 v[64:67], v16 offset:16384
  s_waitcnt lgkmcnt(3)
  v_mfma_f32_32x32x16_bf16 v[40:55], v[180:183], v[68:71], v[40:55]
  ds_read_b128 v[68:71], v17 offset:16384
  s_waitcnt lgkmcnt(3)
  v_mfma_f32_32x32x16_bf16 v[40:55], v[184:187], v[72:75], v[40:55]
  ds_read_b128 v[72:75], v18 offset:16384
  s_waitcnt lgkmcnt(3)
  v_mfma_f32_32x32x16_bf16 v[40:55], v[188:191], v[76:79], v[40:55]
  ds_read_b128 v[76:79], v19 offset:16384
  s_waitcnt lgkmcnt(3)
  v_mfma_f32_32x32x16_bf16 v[40:55], v[192:195], v[64:67], v[40:55]
  ds_read_b128 v[64:67], v20 offset:16384
  s_waitcnt lgkmcnt(3)
  v_mfma_f32_32x32x16_bf16 v[40:55], v[196:199], v[68:71], v[40:55]
  ds_read_b128 v[68:71], v21 offset:16384
  s_waitcnt lgkmcnt(3)
  v_mfma_f32_32x32x16_bf16 v[40:55], v[200:203], v[72:75], v[40:55]
  ds_read_b128 v[72:75], v22 offset:16384
  s_waitcnt lgkmcnt(3)
  v_mfma_f32_32x32x16_bf16 v[40:55], v[204:207], v[76:79], v[40:55]
  ds_read_b128 v[76:79], v23 offset:16384
  s_waitcnt lgkmcnt(3)
  v_mfma_f32_32x32x16_bf16 v[40:55], v[208:211], v[64:67], v[40:55]
  ds_read_b128 v[64:67], v16 offset:24576
  s_waitcnt lgkmcnt(3)
  v_mfma_f32_32x32x16_bf16 v[40:55], v[212:215], v[68:71], v[40:55]
  ds_read_b128 v[68:71], v17 offset:24576
  s_waitcnt lgkmcnt(3)
  v_mfma_f32_32x32x16_bf16 v[40:55], v[216:219], v[72:75], v[40:55]
  ds_read_b128 v[72:75], v18 offset:24576
  s_waitcnt lgkmcnt(3)
  v_mfma_f32_32x32x16_bf16 v[40:55], v[220:223], v[76:79], v[40:55]
  ds_read_b128 v[76:79], v19 offset:24576
  s_waitcnt lgkmcnt(3)
  v_mfma_f32_32x32x16_bf16 v[40:55], v[224:227], v[64:67], v[40:55]
  ds_read_b128 v[64:67], v20 offset:24576
  s_waitcnt lgkmcnt(3)
  v_mfma_f32_32x32x16_bf16 v[40:55], v[228:231], v[68:71], v[40:55]
  ds_read_b128 v[68:71], v21 offset:24576
  s_waitcnt lgkmcnt(3)
  v_mfma_f32_32x32x16_bf16 v[40:55], v[232:235], v[72:75], v[40:55]
  ds_read_b128 v[72:75], v22 offset:24576
  s_waitcnt lgkmcnt(3)
  v_mfma_f32_32x32x16_bf16 v[40:55], v[236:239], v[76:79], v[40:55]
  ds_read_b128 v[76:79], v23 offset:24576
  s_waitcnt lgkmcnt(3)
  v_mfma_f32_32x32x16_bf16 v[40:55], v[240:243], v[64:67], v[40:55]
  s_waitcnt lgkmcnt(2)
  v_mfma_f32_32x32x16_bf16 v[40:55], v[244:247], v[68:71], v[40:55]
  s_waitcnt lgkmcnt(1)
  v_mfma_f32_32x32x16_bf16 v[40:55], v[248:251], v[72:75], v[40:55]
  s_waitcnt lgkmcnt(0)
  s_barrier
  v_mfma_f32_32x32x16_bf16 v[40:55], v[252:255], v[76:79], v[40:55]
  s_nop 11
  v_max3_f32 v56, v40, v41, v42
  v_max3_f32 v57, v43, v44, v45
  v_max3_f32 v58, v46, v47, v48
  v_max3_f32 v59, v49, v50, v51
  v_max3_f32 v56, v56, v52, v53
  v_max3_f32 v57, v57, v54, v55
  v_max3_f32 v56, v56, v57, v58
  v_max_f32 v56, v56, v59
  v_mov_b32 v57, v56
  s_nop 1
  v_permlane32_swap_b32 v56, v57
  v_max_f32 v56, v56, v57
  v_ceil_f32 v36, v56
  ds_write_b32 v29, v36
  v_pk_add_f32 v[40:41], v[40:41], v[36:37] op_sel_hi:[1,0] neg_lo:[0,1] neg_hi:[0,1]
  v_pk_add_f32 v[42:43], v[42:43], v[36:37] op_sel_hi:[1,0] neg_lo:[0,1] neg_hi:[0,1]
  v_pk_add_f32 v[44:45], v[44:45], v[36:37] op_sel_hi:[1,0] neg_lo:[0,1] neg_hi:[0,1]
  v_pk_add_f32 v[46:47], v[46:47], v[36:37] op_sel_hi:[1,0] neg_lo:[0,1] neg_hi:[0,1]
  v_pk_add_f32 v[48:49], v[48:49], v[36:37] op_sel_hi:[1,0] neg_lo:[0,1] neg_hi:[0,1]
  v_pk_add_f32 v[50:51], v[50:51], v[36:37] op_sel_hi:[1,0] neg_lo:[0,1] neg_hi:[0,1]
  v_pk_add_f32 v[52:53], v[52:53], v[36:37] op_sel_hi:[1,0] neg_lo:[0,1] neg_hi:[0,1]
  v_pk_add_f32 v[54:55], v[54:55], v[36:37] op_sel_hi:[1,0] neg_lo:[0,1] neg_hi:[0,1]
  s_waitcnt lgkmcnt(0)
  s_barrier
  ds_read_b128 v[56:59], v28
  v_exp_f32 v40, v40
  v_exp_f32 v41, v41
  v_exp_f32 v42, v42
  v_exp_f32 v43, v43
  v_exp_f32 v44, v44
  v_exp_f32 v45, v45
  v_exp_f32 v46, v46
  v_exp_f32 v47, v47
  v_exp_f32 v48, v48
  v_exp_f32 v49, v49
  v_cvt_pk_bf16_f32 v64, v40, v41
  v_cvt_pk_bf16_f32 v65, v42, v43
  v_cvt_pk_bf16_f32 v66, v44, v45
  v_cvt_pk_bf16_f32 v67, v46, v47
  s_waitcnt lgkmcnt(0)
  v_max3_f32 v56, v56, v57, v58
  v_exp_f32 v50, v50
  v_max_f32 v60, v56, v59
  v_exp_f32 v51, v51
  v_sub_f32 v36, v60, v36
  v_exp_f32 v52, v52
  v_cvt_u32_f32 v57, v36
  v_exp_f32 v53, v53
  v_min_u32 v57, 0xff, v57
  v_exp_f32 v54, v54
  v_mul_u32_u24 v57, 0x800080, v57
  v_exp_f32 v55, v55
  v_pk_sub_u16 v64, v64, v57 clamp
  v_pk_sub_u16 v65, v65, v57 clamp
  v_pk_sub_u16 v66, v66, v57 clamp
  v_pk_sub_u16 v67, v67, v57 clamp
  ds_write_b128 v32, v[64:67]
  v_cvt_pk_bf16_f32 v68, v48, v49
  v_cvt_pk_bf16_f32 v69, v50, v51
  v_cvt_pk_bf16_f32 v70, v52, v53
  v_cvt_pk_bf16_f32 v71, v54, v55
  v_pk_sub_u16 v68, v68, v57 clamp
  v_pk_sub_u16 v69, v69, v57 clamp
  v_pk_sub_u16 v70, v70, v57 clamp
  v_pk_sub_u16 v71, v71, v57 clamp
  ds_write_b128 v32, v[68:71] offset:1024
  s_waitcnt lgkmcnt(0)
  s_barrier
  s_setprio 0
  v_pk_add_f32 v[40:41], v[40:41], v[48:49]
  v_pk_add_f32 v[42:43], v[42:43], v[50:51]
  v_pk_add_f32 v[44:45], v[44:45], v[52:53]
  v_pk_add_f32 v[46:47], v[46:47], v[54:55]
  v_pk_add_f32 v[40:41], v[40:41], v[44:45]
  v_pk_add_f32 v[42:43], v[42:43], v[46:47]
  v_pk_add_f32 v[40:41], v[40:41], v[42:43]
  v_exp_f32 v36, -v36
  v_add_f32 v40, v40, v41
  v_mul_f32 v40, v40, v36
  ds_write_b32 v31, v40
  s_waitcnt lgkmcnt(0)
  s_barrier
  s_barrier
OUTB:
  buffer_load_dwordx4 v[104:107], v30, s[72:75], s27 offen nt
  s_add_u32 s27, s27, 5120
  buffer_load_dwordx4 v[108:111], v30, s[72:75], s27 offen nt
  s_add_u32 s27, s27, 5120
  buffer_load_dwordx4 v[112:115], v30, s[4:7], s26 offen nt
  s_add_u32 s26, s26, 5120
  buffer_load_dwordx4 v[116:119], v30, s[4:7], s26 offen nt
  s_add_u32 s26, s26, 5120
  buffer_load_dwordx4 v[120:123], v30, s[4:7], s26 offen nt
  s_add_u32 s26, s26, 5120
  buffer_load_dwordx4 v[124:127], v30, s[4:7], s26 offen nt
  s_add_u32 s26, s26, 5120
  v_mov_b32 v2, v33
  v_mov_b32 v3, v34
  v_and_b32 v25, 1, v3
  v_cmp_eq_u32 vcc, 1, v25
  v_mov_b32 v26, 0x0c0c0100
  v_mov_b32 v25, 0x01000c0c
  v_cndmask_b32 v26, v26, v25, vcc
  v_mov_b32 v27, 0x0c0c0302
  v_mov_b32 v25, 0x03020c0c
  v_cndmask_b32 v27, v27, v25, vcc
  v_bfe_u32 v25, v3, 2, 1
  v_cmp_eq_u32 vcc, 0, v25
  v_mov_b32 v20, 0x0c0c0c0c
  v_mov_b32 v22, 0x0c0c0c0c
  v_cndmask_b32 v20, v20, v26, vcc
  v_cndmask_b32 v22, v22, v27, vcc
  v_cmp_eq_u32 vcc, 1, v25
  v_mov_b32 v21, 0x0c0c0c0c
  v_mov_b32 v23, 0x0c0c0c0c
  v_cndmask_b32 v21, v21, v26, vcc
  v_cndmask_b32 v23, v23, v27, vcc
  v_and_b32 v25, 2, v3
  v_cmp_eq_u32 vcc, 2, v25
  v_mov_b32 v24, 0x4444
  v_mov_b32 v25, 0xeeee
  v_cndmask_b32 v24, v24, v25, vcc
  s_mov_b32 s70, 0x07060302
  s_mov_b32 s71, 0x0c0c0501
  s_mov_b32 s69, 0x05010c0c
  v_and_b32 v13, 3, v0
  v_and_b32 v15, 12, v3
  v_add_u32 v15, v15, v2
  v_lshlrev_b32 v15, 4, v15
  v_lshl_add_u32 v15, v13, 10, v15
  s_lshl_b32 s37, s30, 12
  s_lshl_b32 s14, s31, 8
  s_add_u32 s37, s37, s14
  s_add_u32 s37, s37, 4096
  v_lshlrev_b32 v19, 5, v3
  v_lshl_add_u32 v19, v2, 4, v19
  v_lshlrev_b32 v4, 4, v2
  s_mul_i32 s15, s33, 2560
  s_lshl_b32 s14, s36, 9
  s_add_u32 s15, s15, s14
  s_add_u32 s15, s15, 589824
  s_lshl_b32 s38, s33, 7
  s_add_u32 s38, s38, 196608
  v_mov_b32 v60, 0
  v_mov_b32 v61, 0
  v_mov_b32 v62, 0
  v_mov_b32 v63, 0
  v_mov_b32 v64, 0
  v_mov_b32 v65, 0
  v_mov_b32 v66, 0
  v_mov_b32 v67, 0
  v_mov_b32 v71, s24
  s_cmp_lt_u32 s34, 108
  s_cselect_b64 s[28:29], -1, 0
  s_mov_b32 s25, 200000
  s_add_u32 s12, s38, 6291456
O_HP:
  buffer_load_dwordx4 v[184:187], v4, s[16:19], s12 offen sc1
  buffer_load_dwordx4 v[188:191], off, s[16:19], s12 offset:64 sc1
  s_waitcnt vmcnt(0)
  v_xor_b32 v31, s24, v185
  v_bitop3_b32 v31, v187, s24, v31 bitop3:0xbe
  v_cndmask_b32 v31, 0, v31, s[28:29]
  v_bitop3_b32 v31, v191, s24, v31 bitop3:0xbe
  v_cmp_ne_u32 vcc, 0, v31
  s_cbranch_vccz O_HP_OK
  s_sub_u32 s25, s25, 1
  s_cmp_gt_u32 s25, 199980
  s_cbranch_scc1 O_HP
  s_and_b32 s12, s25, 1
  s_cselect_b32 s12, 0, 6291456
  s_add_u32 s12, s12, s38
  s_cmp_lg_u32 s25, 0
  s_cbranch_scc1 O_HP
O_HP_OK:
  v_cndmask_b32 v184, 0, v184, s[28:29]
  v_cndmask_b32 v186, 0, v186, s[28:29]
  v_perm_b32 v44, v184, v184, v20
  v_perm_b32 v45, v184, v184, v21
  v_perm_b32 v46, v184, v184, v22
  v_perm_b32 v47, v184, v184, v23
  v_perm_b32 v48, v186, v186, v20
  v_perm_b32 v49, v186, v186, v21
  v_perm_b32 v50, v186, v186, v22
  v_perm_b32 v51, v186, v186, v23
  s_nop 0
  v_smfmac_f32_16x16x64_bf16 v[64:67], v[44:47], v[112:119], v24
  v_smfmac_f32_16x16x64_bf16 v[64:67], v[48:51], v[120:127], v24
  s_mov_b32 s25, 200000
  s_add_u32 s12, s37, 6291456
O_CP:
  buffer_load_dwordx4 v[32:35], v15, s[16:19], s12 offen sc1
  s_waitcnt vmcnt(0)
  v_xor_b32 v31, s24, v33
  v_bitop3_b32 v31, v35, s24, v31 bitop3:0xbe
  v_cmp_ne_u32 vcc, 0, v31
  s_cbranch_vccz O_CP_OK
  s_sub_u32 s25, s25, 1
  s_cmp_gt_u32 s25, 199940
  s_cbranch_scc1 O_CP
  s_and_b32 s12, s25, 1
  s_cselect_b32 s12, 0, 6291456
  s_add_u32 s12, s12, s37
  s_cmp_lg_u32 s25, 0
  s_cbranch_scc1 O_CP
O_CP_OK:
  v_add_f32_dpp v32, v32, v32 quad_perm:[1,0,3,2] row_mask:0xf bank_mask:0xf
  v_add_f32_dpp v34, v34, v34 quad_perm:[1,0,3,2] row_mask:0xf bank_mask:0xf
  s_nop 0
  v_add_f32_dpp v32, v32, v32 quad_perm:[2,3,0,1] row_mask:0xf bank_mask:0xf
  v_add_f32_dpp v34, v34, v34 quad_perm:[2,3,0,1] row_mask:0xf bank_mask:0xf
  s_nop 0
  v_cvt_pk_bf16_f32 v32, v32, v34
  s_nop 1
  v_mov_b32_dpp v28, v32 row_newbcast:0 row_mask:0xf bank_mask:0xf
  v_mov_b32_dpp v29, v32 row_newbcast:4 row_mask:0xf bank_mask:0xf
  v_mov_b32_dpp v30, v32 row_newbcast:8 row_mask:0xf bank_mask:0xf
  v_mov_b32_dpp v31, v32 row_newbcast:12 row_mask:0xf bank_mask:0xf
  v_perm_b32 v40, v28, v28, v20
  v_perm_b32 v41, v28, v28, v21
  v_perm_b32 v42, v28, v28, v22
  v_perm_b32 v43, v28, v28, v23
  v_perm_b32 v44, v29, v29, v20
  v_perm_b32 v45, v29, v29, v21
  v_perm_b32 v46, v29, v29, v22
  v_perm_b32 v47, v29, v29, v23
  v_perm_b32 v48, v30, v30, v20
  v_perm_b32 v49, v30, v30, v21
  v_perm_b32 v50, v30, v30, v22
  v_perm_b32 v51, v30, v30, v23
  v_perm_b32 v52, v31, v31, v20
  v_perm_b32 v53, v31, v31, v21
  v_perm_b32 v54, v31, v31, v22
  v_perm_b32 v55, v31, v31, v23
  v_smfmac_f32_16x16x64_bf16 v[60:63], v[40:43], v[80:87], v24
  v_smfmac_f32_16x16x64_bf16 v[60:63], v[44:47], v[88:95], v24
  v_smfmac_f32_16x16x64_bf16 v[60:63], v[48:51], v[96:103], v24
  v_smfmac_f32_16x16x64_bf16 v[60:63], v[52:55], v[104:111], v24
  v_pk_mul_f32 v[64:65], v[64:65], v[188:189] op_sel:[0,1] op_sel_hi:[1,1]
  v_pk_mul_f32 v[66:67], v[66:67], v[188:189] op_sel:[0,1] op_sel_hi:[1,1]
  s_nop 5
  v_pk_fma_f32 v[60:61], v[60:61], v[188:189], v[64:65] op_sel_hi:[1,0,1]
  v_pk_fma_f32 v[62:63], v[62:63], v[188:189], v[66:67] op_sel_hi:[1,0,1]
  v_perm_b32 v68, v61, v60, s70
  v_perm_b32 v69, v63, v62, s70
  v_perm_b32 v38, v61, v60, s71
  v_perm_b32 v70, v63, v62, s69
  v_or_b32 v70, v70, v38
  s_mov_b32 exec_hi, 0
  buffer_store_dwordx4 v[68:71], v19, s[16:19], s15 offen sc1
  s_mov_b64 exec, -1
  s_endpgm
SIDE:
  v_lshlrev_b32 v62, 4, v0
  s_lshl_b32 s9, s3, 12
  s_add_u32 s9, s9, 262144
  s_add_u32 s10, s9, 16384
  s_add_u32 s11, s9, 32768
  v_and_b32 v2, 31, v0
  v_lshrrev_b32 v3, 5, v0
  v_and_b32 v5, 7, v0
  v_xor_b32 v4, v3, v5
  v_lshlrev_b32 v4, 4, v4
  v_lshl_add_u32 v4, v2, 10, v4
  s_lshl_b32 s8, s3, 7
  s_add_u32 s8, s8, 131072
  v_add_u32 v4, s8, v4
  v_xor_b32 v5, 32, v4
  v_xor_b32 v6, 64, v4
  v_xor_b32 v7, 96, v4
  v_bfe_u32 v8, v0, 2, 3
  v_bfe_u32 v9, v0, 1, 1
  v_lshlrev_b32 v10, 1, v8
  v_xor_b32 v9, v9, v10
  v_lshlrev_b32 v9, 4, v9
  v_lshl_add_u32 v8, v3, 4, v8
  v_lshl_add_u32 v9, v8, 10, v9
  v_and_b32 v10, 1, v0
  v_lshl_add_u32 v9, v10, 3, v9
  s_lshl_b32 s12, s3, 8
  v_add_u32 v24, s12, v9
  v_add_u32 v25, 0x10000, v24
  v_bfe_u32 v2, v0, 3, 1
  v_bfe_u32 v8, v0, 2, 1
  v_lshl_add_u32 v2, v8, 1, v2
  v_lshrrev_b32 v8, 4, v0
  v_lshl_add_u32 v2, v8, 2, v2
  v_bfe_u32 v8, v0, 1, 1
  v_lshl_add_u32 v2, v8, 4, v2
  v_cmp_ne_u32 s[38:39], 0, v8
  v_and_b32 v8, 15, v0
  v_add_u32 v38, s24, v8
  s_mov_b32 s12, 0x9e3779b1
  v_mul_lo_u32 v38, v38, s12
  v_lshlrev_b32 v35, 4, v2
  v_add_u32 v36, 139264, v35
  v_lshlrev_b32 v9, 5, v2
  v_add_u32 v37, 140288, v9
  v_bfe_u32 v9, v0, 4, 1
  v_lshl_add_u32 v9, v9, 5, v8
  v_lshl_add_u32 v9, v3, 6, v9
  v_lshlrev_b32 v9, 4, v9
  v_add_u32 v33, 131072, v9
  v_lshrrev_b32 v9, 4, v0
  v_lshlrev_b32 v9, 19, v9
  v_lshl_add_u32 v34, v8, 4, v9
  s_lshl_b32 s13, s3, 15
  s_lshl_b32 s12, s33, 8
  s_add_u32 s13, s13, s12
  s_add_u32 s13, s13, 2097152
  v_and_b32 v35, 7, v2
  v_lshlrev_b32 v35, 8, v35
  v_lshrrev_b32 v9, 3, v2
  v_lshl_add_u32 v35, v9, 4, v35
  s_lshl_b32 s14, s3, 6
  s_lshl_b32 s12, s33, 11
  s_add_u32 s14, s14, s12
  s_add_u32 s14, s14, 327680
  v_lshlrev_b32 v39, 2, v0
  s_lshl_b32 s15, s33, 7
  s_add_u32 s15, s15, 6520832
  v_cmp_lt_u32 vcc, 0, v0
  s_cmp_lg_u32 s3, 0
  s_cselect_b64 vcc, -1, vcc
  v_cndmask_b32 v39, v39, 2.0, vcc
  s_waitcnt vmcnt(0)
  s_barrier
  s_mov_b32 s25, 200000
  buffer_load_dwordx4 v[200:203], v62, s[16:19], s9 offen offset:0 sc1
  buffer_load_dwordx4 v[204:207], v62, s[16:19], s10 offen offset:0 sc1
  buffer_load_dwordx4 v[208:211], v62, s[16:19], s11 offen offset:0 sc1
  buffer_load_dwordx4 v[212:215], v62, s[16:19], s9 offen offset:1024 sc1
  buffer_load_dwordx4 v[216:219], v62, s[16:19], s10 offen offset:1024 sc1
  buffer_load_dwordx4 v[220:223], v62, s[16:19], s11 offen offset:1024 sc1
  buffer_load_dwordx4 v[224:227], v62, s[16:19], s9 offen offset:2048 sc1
  buffer_load_dwordx4 v[228:231], v62, s[16:19], s10 offen offset:2048 sc1
  buffer_load_dwordx4 v[232:235], v62, s[16:19], s11 offen offset:2048 sc1
  buffer_load_dwordx4 v[236:239], v62, s[16:19], s9 offen offset:3072 sc1
  buffer_load_dwordx4 v[240:243], v62, s[16:19], s10 offen offset:3072 sc1
  buffer_load_dwordx4 v[244:247], v62, s[16:19], s11 offen offset:3072 sc1
  s_waitcnt vmcnt(11)
  v_xor_b32 v28, s24, v203
  ds_write_b96 v4, v[200:202] offset:0
  s_waitcnt vmcnt(10)
  v_bitop3_b32 v28, v207, s24, v28 bitop3:0xbe
  ds_write_b96 v4, v[204:206] offset:512
  s_waitcnt vmcnt(9)
  v_bitop3_b32 v28, v211, s24, v28 bitop3:0xbe
  ds_write2_b32 v4, v208, v209 offset0:3 offset1:131
  s_waitcnt vmcnt(8)
  v_xor_b32 v29, s24, v215
  ds_write_b96 v5, v[212:214] offset:0
  s_waitcnt vmcnt(7)
  v_bitop3_b32 v29, v219, s24, v29 bitop3:0xbe
  ds_write_b96 v5, v[216:218] offset:512
  s_waitcnt vmcnt(6)
  v_bitop3_b32 v29, v223, s24, v29 bitop3:0xbe
  ds_write2_b32 v5, v220, v221 offset0:3 offset1:131
  s_waitcnt vmcnt(5)
  v_xor_b32 v30, s24, v227
  ds_write_b96 v6, v[224:226] offset:0
  s_waitcnt vmcnt(4)
  v_bitop3_b32 v30, v231, s24, v30 bitop3:0xbe
  ds_write_b96 v6, v[228:230] offset:512
  s_waitcnt vmcnt(3)
  v_bitop3_b32 v30, v235, s24, v30 bitop3:0xbe
  ds_write2_b32 v6, v232, v233 offset0:3 offset1:131
  s_waitcnt vmcnt(2)
  v_xor_b32 v31, s24, v239
  ds_write_b96 v7, v[236:238] offset:0
  s_waitcnt vmcnt(1)
  v_bitop3_b32 v31, v243, s24, v31 bitop3:0xbe
  ds_write_b96 v7, v[240:242] offset:512
  s_waitcnt vmcnt(0)
  v_bitop3_b32 v31, v247, s24, v31 bitop3:0xbe
  ds_write2_b32 v7, v244, v245 offset0:3 offset1:131
S_QRT:
  v_or3_b32 v27, v28, v29, v30
  v_or_b32 v27, v27, v31
  v_cmp_ne_u32 vcc, 0, v27
  s_cbranch_vccz S_QOK
  s_waitcnt lgkmcnt(0)
  v_cmp_ne_u32 vcc, 0, v28
  s_cbranch_vccz S_QA0
  buffer_load_dwordx4 v[200:203], v62, s[16:19], s9 offen offset:0 sc1
  buffer_load_dwordx4 v[204:207], v62, s[16:19], s10 offen offset:0 sc1
  buffer_load_dwordx4 v[208:211], v62, s[16:19], s11 offen offset:0 sc1
S_QA0:
  v_cmp_ne_u32 vcc, 0, v29
  s_cbranch_vccz S_QA1
  buffer_load_dwordx4 v[212:215], v62, s[16:19], s9 offen offset:1024 sc1
  buffer_load_dwordx4 v[216:219], v62, s[16:19], s10 offen offset:1024 sc1
  buffer_load_dwordx4 v[220:223], v62, s[16:19], s11 offen offset:1024 sc1
S_QA1:
  v_cmp_ne_u32 vcc, 0, v30
  s_cbranch_vccz S_QA2
  buffer_load_dwordx4 v[224:227], v62, s[16:19], s9 offen offset:2048 sc1
  buffer_load_dwordx4 v[228:231], v62, s[16:19], s10 offen offset:2048 sc1
  buffer_load_dwordx4 v[232:235], v62, s[16:19], s11 offen offset:2048 sc1
S_QA2:
  v_cmp_ne_u32 vcc, 0, v31
  s_cbranch_vccz S_QA3
  buffer_load_dwordx4 v[236:239], v62, s[16:19], s9 offen offset:3072 sc1
  buffer_load_dwordx4 v[240:243], v62, s[16:19], s10 offen offset:3072 sc1
  buffer_load_dwordx4 v[244:247], v62, s[16:19], s11 offen offset:3072 sc1
S_QA3:
  s_waitcnt vmcnt(0)
  v_cmp_ne_u32 vcc, 0, v28
  s_cbranch_vccz S_QB0
  v_xor_b32 v28, s24, v203
  ds_write_b96 v4, v[200:202] offset:0
  v_bitop3_b32 v28, v207, s24, v28 bitop3:0xbe
  ds_write_b96 v4, v[204:206] offset:512
  v_bitop3_b32 v28, v211, s24, v28 bitop3:0xbe
  ds_write2_b32 v4, v208, v209 offset0:3 offset1:131
S_QB0:
  v_cmp_ne_u32 vcc, 0, v29
  s_cbranch_vccz S_QB1
  v_xor_b32 v29, s24, v215
  ds_write_b96 v5, v[212:214] offset:0
  v_bitop3_b32 v29, v219, s24, v29 bitop3:0xbe
  ds_write_b96 v5, v[216:218] offset:512
  v_bitop3_b32 v29, v223, s24, v29 bitop3:0xbe
  ds_write2_b32 v5, v220, v221 offset0:3 offset1:131
S_QB1:
  v_cmp_ne_u32 vcc, 0, v30
  s_cbranch_vccz S_QB2
  v_xor_b32 v30, s24, v227
  ds_write_b96 v6, v[224:226] offset:0
  v_bitop3_b32 v30, v231, s24, v30 bitop3:0xbe
  ds_write_b96 v6, v[228:230] offset:512
  v_bitop3_b32 v30, v235, s24, v30 bitop3:0xbe
  ds_write2_b32 v6, v232, v233 offset0:3 offset1:131
S_QB2:
  v_cmp_ne_u32 vcc, 0, v31
  s_cbranch_vccz S_QB3
  v_xor_b32 v31, s24, v239
  ds_write_b96 v7, v[236:238] offset:0
  v_bitop3_b32 v31, v243, s24, v31 bitop3:0xbe
  ds_write_b96 v7, v[240:242] offset:512
  v_bitop3_b32 v31, v247, s24, v31 bitop3:0xbe
  ds_write2_b32 v7, v244, v245 offset0:3 offset1:131
S_QB3:
  s_sub_u32 s25, s25, 1
  s_cmp_lg_u32 s25, 0
  s_cbranch_scc1 S_QRT
S_QOK:
  s_waitcnt lgkmcnt(0)
  s_barrier
  v_xor_b32 v26, 0, v24
  v_xor_b32 v27, 16, v24
  ds_read_b64_tr_b16 v[128:129], v26 offset:0
  ds_read_b64_tr_b16 v[130:131], v27 offset:8192
  ds_read_b64_tr_b16 v[132:133], v26 offset:32768
  ds_read_b64_tr_b16 v[134:135], v27 offset:40960
  v_xor_b32 v26, 32, v24
  v_xor_b32 v27, 48, v24
  ds_read_b64_tr_b16 v[136:137], v26 offset:0
  ds_read_b64_tr_b16 v[138:139], v27 offset:8192
  ds_read_b64_tr_b16 v[140:141], v26 offset:32768
  ds_read_b64_tr_b16 v[142:143], v27 offset:40960
  v_xor_b32 v26, 64, v24
  v_xor_b32 v27, 80, v24
  ds_read_b64_tr_b16 v[144:145], v26 offset:0
  ds_read_b64_tr_b16 v[146:147], v27 offset:8192
  ds_read_b64_tr_b16 v[148:149], v26 offset:32768
  ds_read_b64_tr_b16 v[150:151], v27 offset:40960
  v_xor_b32 v26, 96, v24
  v_xor_b32 v27, 112, v24
  ds_read_b64_tr_b16 v[152:153], v26 offset:0
  ds_read_b64_tr_b16 v[154:155], v27 offset:8192
  ds_read_b64_tr_b16 v[156:157], v26 offset:32768
  ds_read_b64_tr_b16 v[158:159], v27 offset:40960
  v_xor_b32 v26, 128, v24
  v_xor_b32 v27, 144, v24
  ds_read_b64_tr_b16 v[160:161], v26 offset:0
  ds_read_b64_tr_b16 v[162:163], v27 offset:8192
  ds_read_b64_tr_b16 v[164:165], v26 offset:32768
  ds_read_b64_tr_b16 v[166:167], v27 offset:40960
  v_xor_b32 v26, 160, v24
  v_xor_b32 v27, 176, v24
  ds_read_b64_tr_b16 v[168:169], v26 offset:0
  ds_read_b64_tr_b16 v[170:171], v27 offset:8192
  ds_read_b64_tr_b16 v[172:173], v26 offset:32768
  ds_read_b64_tr_b16 v[174:175], v27 offset:40960
  v_xor_b32 v26, 192, v24
  v_xor_b32 v27, 208, v24
  ds_read_b64_tr_b16 v[176:177], v26 offset:0
  ds_read_b64_tr_b16 v[178:179], v27 offset:8192
  ds_read_b64_tr_b16 v[180:181], v26 offset:32768
  ds_read_b64_tr_b16 v[182:183], v27 offset:40960
  v_xor_b32 v26, 224, v24
  v_xor_b32 v27, 240, v24
  ds_read_b64_tr_b16 v[184:185], v26 offset:0
  ds_read_b64_tr_b16 v[186:187], v27 offset:8192
  ds_read_b64_tr_b16 v[188:189], v26 offset:32768
  ds_read_b64_tr_b16 v[190:191], v27 offset:40960
  v_xor_b32 v26, 0, v25
  v_xor_b32 v27, 16, v25
  ds_read_b64_tr_b16 v[192:193], v26 offset:0
  ds_read_b64_tr_b16 v[194:195], v27 offset:8192
  ds_read_b64_tr_b16 v[196:197], v26 offset:32768
  ds_read_b64_tr_b16 v[198:199], v27 offset:40960
  v_xor_b32 v26, 32, v25
  v_xor_b32 v27, 48, v25
  ds_read_b64_tr_b16 v[200:201], v26 offset:0
  ds_read_b64_tr_b16 v[202:203], v27 offset:8192
  ds_read_b64_tr_b16 v[204:205], v26 offset:32768
  ds_read_b64_tr_b16 v[206:207], v27 offset:40960
  v_xor_b32 v26, 64, v25
  v_xor_b32 v27, 80, v25
  ds_read_b64_tr_b16 v[208:209], v26 offset:0
  ds_read_b64_tr_b16 v[210:211], v27 offset:8192
  ds_read_b64_tr_b16 v[212:213], v26 offset:32768
  ds_read_b64_tr_b16 v[214:215], v27 offset:40960
  v_xor_b32 v26, 96, v25
  v_xor_b32 v27, 112, v25
  ds_read_b64_tr_b16 v[216:217], v26 offset:0
  ds_read_b64_tr_b16 v[218:219], v27 offset:8192
  ds_read_b64_tr_b16 v[220:221], v26 offset:32768
  ds_read_b64_tr_b16 v[222:223], v27 offset:40960
  s_barrier
  s_barrier
  ds_read_b128 v[56:59], v36
  v_mov_b32 v63, s24
  v_xor_b32 v26, 128, v25
  v_xor_b32 v27, 144, v25
  ds_read_b64_tr_b16 v[224:225], v26 offset:0
  ds_read_b64_tr_b16 v[226:227], v27 offset:8192
  ds_read_b64_tr_b16 v[228:229], v26 offset:32768
  ds_read_b64_tr_b16 v[230:231], v27 offset:40960
  v_xor_b32 v26, 160, v25
  v_xor_b32 v27, 176, v25
  ds_read_b64_tr_b16 v[232:233], v26 offset:0
  ds_read_b64_tr_b16 v[234:235], v27 offset:8192
  ds_read_b64_tr_b16 v[236:237], v26 offset:32768
  ds_read_b64_tr_b16 v[238:239], v27 offset:40960
  v_xor_b32 v26, 192, v25
  v_xor_b32 v27, 208, v25
  ds_read_b64_tr_b16 v[240:241], v26 offset:0
  ds_read_b64_tr_b16 v[242:243], v27 offset:8192
  ds_read_b64_tr_b16 v[244:245], v26 offset:32768
  ds_read_b64_tr_b16 v[246:247], v27 offset:40960
  v_xor_b32 v26, 224, v25
  v_xor_b32 v27, 240, v25
  ds_read_b64_tr_b16 v[248:249], v26 offset:0
  ds_read_b64_tr_b16 v[250:251], v27 offset:8192
  ds_read_b64_tr_b16 v[252:253], v26 offset:32768
  ds_read_b64_tr_b16 v[254:255], v27 offset:40960
  s_waitcnt lgkmcnt(0)
  v_max3_f32 v56, v56, v57, v58
  v_max_f32 v60, v56, v59
  s_setprio 2
  s_barrier
  ds_read_b128 v[64:67], v33 offset:0
  ds_read_b128 v[68:71], v33 offset:2048
  ds_read_b128 v[72:75], v33 offset:4096
  ds_read_b128 v[76:79], v33 offset:6144
  ds_read_b128 v[80:83], v33 offset:256
  ds_read_b128 v[84:87], v33 offset:2304
  ds_read_b128 v[88:91], v33 offset:4352
  ds_read_b128 v[92:95], v33 offset:6400
  s_waitcnt lgkmcnt(7)
  v_mfma_f32_16x16x32_bf16 v[96:99], v[64:67], v[128:131], 0
  s_waitcnt lgkmcnt(6)
  v_mfma_f32_16x16x32_bf16 v[96:99], v[68:71], v[132:135], v[96:99]
  s_waitcnt lgkmcnt(5)
  v_mfma_f32_16x16x32_bf16 v[96:99], v[72:75], v[192:195], v[96:99]
  s_waitcnt lgkmcnt(4)
  v_mfma_f32_16x16x32_bf16 v[96:99], v[76:79], v[196:199], v[96:99]
  v_mfma_f32_16x16x32_bf16 v[100:103], v[64:67], v[136:139], 0
  v_mfma_f32_16x16x32_bf16 v[100:103], v[68:71], v[140:143], v[100:103]
  v_mfma_f32_16x16x32_bf16 v[100:103], v[72:75], v[200:203], v[100:103]
  v_mfma_f32_16x16x32_bf16 v[100:103], v[76:79], v[204:207], v[100:103]
  s_nop 0
  s_nop 0
  v_mfma_f32_16x16x32_bf16 v[104:107], v[64:67], v[144:147], 0
  s_nop 0
  s_nop 0
  v_mfma_f32_16x16x32_bf16 v[104:107], v[68:71], v[148:151], v[104:107]
  s_nop 0
  s_nop 0
  v_mfma_f32_16x16x32_bf16 v[104:107], v[72:75], v[208:211], v[104:107]
  v_cvt_pk_bf16_f32 v40, v96, v100
  v_cvt_pk_bf16_f32 v44, v97, v101
  v_mfma_f32_16x16x32_bf16 v[104:107], v[76:79], v[212:215], v[104:107]
  v_cvt_pk_bf16_f32 v48, v98, v102
  v_cvt_pk_bf16_f32 v52, v99, v103
  v_mfma_f32_16x16x32_bf16 v[108:111], v[64:67], v[152:155], 0
  v_xor_b32 v40, v38, v40
  v_xor_b32 v44, v38, v44
  v_mfma_f32_16x16x32_bf16 v[108:111], v[68:71], v[156:159], v[108:111]
  v_xor_b32 v48, v38, v48
  v_xor_b32 v52, v38, v52
  v_mfma_f32_16x16x32_bf16 v[108:111], v[72:75], v[216:219], v[108:111]
  v_mfma_f32_16x16x32_bf16 v[108:111], v[76:79], v[220:223], v[108:111]
  s_nop 0
  s_nop 0
  v_mfma_f32_16x16x32_bf16 v[112:115], v[64:67], v[160:163], 0
  s_nop 0
  s_nop 0
  v_mfma_f32_16x16x32_bf16 v[112:115], v[68:71], v[164:167], v[112:115]
  s_nop 0
  s_nop 0
  v_mfma_f32_16x16x32_bf16 v[112:115], v[72:75], v[224:227], v[112:115]
  v_cvt_pk_bf16_f32 v41, v104, v108
  v_cvt_pk_bf16_f32 v45, v105, v109
  v_mfma_f32_16x16x32_bf16 v[112:115], v[76:79], v[228:231], v[112:115]
  v_cvt_pk_bf16_f32 v49, v106, v110
  v_cvt_pk_bf16_f32 v53, v107, v111
  v_mfma_f32_16x16x32_bf16 v[116:119], v[64:67], v[168:171], 0
  v_xor_b32 v41, v38, v41
  v_xor_b32 v45, v38, v45
  v_mfma_f32_16x16x32_bf16 v[116:119], v[68:71], v[172:175], v[116:119]
  v_xor_b32 v49, v38, v49
  v_xor_b32 v53, v38, v53
  v_mfma_f32_16x16x32_bf16 v[116:119], v[72:75], v[232:235], v[116:119]
  v_mfma_f32_16x16x32_bf16 v[116:119], v[76:79], v[236:239], v[116:119]
  s_nop 0
  s_nop 0
  v_mfma_f32_16x16x32_bf16 v[120:123], v[64:67], v[176:179], 0
  s_nop 0
  s_nop 0
  v_mfma_f32_16x16x32_bf16 v[120:123], v[68:71], v[180:183], v[120:123]
  s_nop 0
  s_nop 0
  v_mfma_f32_16x16x32_bf16 v[120:123], v[72:75], v[240:243], v[120:123]
  v_cvt_pk_bf16_f32 v42, v112, v116
  v_cvt_pk_bf16_f32 v46, v113, v117
  v_mfma_f32_16x16x32_bf16 v[120:123], v[76:79], v[244:247], v[120:123]
  v_cvt_pk_bf16_f32 v50, v114, v118
  v_cvt_pk_bf16_f32 v54, v115, v119
  v_mfma_f32_16x16x32_bf16 v[124:127], v[64:67], v[184:187], 0
  v_xor_b32 v42, v38, v42
  v_xor_b32 v46, v38, v46
  v_mfma_f32_16x16x32_bf16 v[124:127], v[68:71], v[188:191], v[124:127]
  v_xor_b32 v50, v38, v50
  v_xor_b32 v54, v38, v54
  v_mfma_f32_16x16x32_bf16 v[124:127], v[72:75], v[248:251], v[124:127]
  v_add3_u32 v4, v40, v41, v42
  v_add3_u32 v5, v44, v45, v46
  v_mfma_f32_16x16x32_bf16 v[124:127], v[76:79], v[252:255], v[124:127]
  v_add3_u32 v6, v48, v49, v50
  v_add3_u32 v7, v52, v53, v54
  s_waitcnt lgkmcnt(0)
  s_barrier
  ds_read_b128 v[112:115], v37
  ds_read_b128 v[116:119], v37 offset:16
  v_mfma_f32_16x16x32_bf16 v[8:11], v[80:83], v[128:131], 0
  s_nop 0
  v_cvt_pk_bf16_f32 v43, v120, v124
  v_mfma_f32_16x16x32_bf16 v[8:11], v[84:87], v[132:135], v[8:11]
  v_cvt_pk_bf16_f32 v47, v121, v125
  v_cvt_pk_bf16_f32 v51, v122, v126
  v_mfma_f32_16x16x32_bf16 v[8:11], v[88:91], v[192:195], v[8:11]
  v_cvt_pk_bf16_f32 v55, v123, v127
  v_xor_b32 v43, v38, v43
  v_mfma_f32_16x16x32_bf16 v[8:11], v[92:95], v[196:199], v[8:11]
  v_xor_b32 v47, v38, v47
  v_xor_b32 v51, v38, v51
  v_mfma_f32_16x16x32_bf16 v[12:15], v[80:83], v[136:139], 0
  v_xor_b32 v55, v38, v55
  v_add_u32 v4, v4, v43
  v_mfma_f32_16x16x32_bf16 v[12:15], v[84:87], v[140:143], v[12:15]
  s_add_u32 s11, s13, 0
  buffer_store_dwordx4 v[40:43], v34, s[16:19], s11 offen sc1
  v_mfma_f32_16x16x32_bf16 v[12:15], v[88:91], v[200:203], v[12:15]
  v_add_u32 v5, v5, v47
  v_add_u32 v6, v6, v51
  v_mfma_f32_16x16x32_bf16 v[12:15], v[92:95], v[204:207], v[12:15]
  v_add_u32 v7, v7, v55
  v_add_u32_dpp v4, v4, v4 row_ror:8 row_mask:0xf bank_mask:0x3
  v_mfma_f32_16x16x32_bf16 v[16:19], v[80:83], v[144:147], 0
  v_add_u32_dpp v6, v6, v6 row_ror:8 row_mask:0xf bank_mask:0x3
  v_add_u32_dpp v4, v5, v5 row_ror:8 row_mask:0xf bank_mask:0xc
  v_mfma_f32_16x16x32_bf16 v[16:19], v[84:87], v[148:151], v[16:19]
  s_add_u32 s11, s13, 131072
  buffer_store_dwordx4 v[44:47], v34, s[16:19], s11 offen sc1
  v_mfma_f32_16x16x32_bf16 v[16:19], v[88:91], v[208:211], v[16:19]
  v_cvt_pk_bf16_f32 v96, v8, v12
  v_cvt_pk_bf16_f32 v100, v9, v13
  v_mfma_f32_16x16x32_bf16 v[16:19], v[92:95], v[212:215], v[16:19]
  v_cvt_pk_bf16_f32 v104, v10, v14
  v_cvt_pk_bf16_f32 v108, v11, v15
  v_mfma_f32_16x16x32_bf16 v[20:23], v[80:83], v[152:155], 0
  v_xor_b32 v96, v38, v96
  v_xor_b32 v100, v38, v100
  v_mfma_f32_16x16x32_bf16 v[20:23], v[84:87], v[156:159], v[20:23]
  s_add_u32 s11, s13, 262144
  buffer_store_dwordx4 v[48:51], v34, s[16:19], s11 offen sc1
  v_mfma_f32_16x16x32_bf16 v[20:23], v[88:91], v[216:219], v[20:23]
  v_xor_b32 v104, v38, v104
  v_xor_b32 v108, v38, v108
  v_mfma_f32_16x16x32_bf16 v[20:23], v[92:95], v[220:223], v[20:23]
  v_add_u32_dpp v6, v7, v7 row_ror:8 row_mask:0xf bank_mask:0xc
  s_nop 0
  v_mfma_f32_16x16x32_bf16 v[64:67], v[80:83], v[160:163], 0
  v_add_u32_dpp v4, v4, v4 row_half_mirror row_mask:0xf bank_mask:0x5
  v_add_u32_dpp v4, v6, v6 row_half_mirror row_mask:0xf bank_mask:0xa
  v_mfma_f32_16x16x32_bf16 v[64:67], v[84:87], v[164:167], v[64:67]
  s_add_u32 s11, s13, 393216
  buffer_store_dwordx4 v[52:55], v34, s[16:19], s11 offen sc1
  v_mfma_f32_16x16x32_bf16 v[64:67], v[88:91], v[224:227], v[64:67]
  v_cvt_pk_bf16_f32 v97, v16, v20
  v_cvt_pk_bf16_f32 v101, v17, v21
  v_mfma_f32_16x16x32_bf16 v[64:67], v[92:95], v[228:231], v[64:67]
  v_cvt_pk_bf16_f32 v105, v18, v22
  v_cvt_pk_bf16_f32 v109, v19, v23
  v_mfma_f32_16x16x32_bf16 v[68:71], v[80:83], v[168:171], 0
  v_xor_b32 v97, v38, v97
  v_xor_b32 v101, v38, v101
  v_mfma_f32_16x16x32_bf16 v[68:71], v[84:87], v[172:175], v[68:71]
  v_xor_b32 v105, v38, v105
  v_xor_b32 v109, v38, v109
  v_mfma_f32_16x16x32_bf16 v[68:71], v[88:91], v[232:235], v[68:71]
  s_nop 1
  v_add_u32_dpp v4, v4, v4 quad_perm:[2,3,0,1] row_mask:0xf bank_mask:0xf
  v_mfma_f32_16x16x32_bf16 v[68:71], v[92:95], v[236:239], v[68:71]
  s_waitcnt lgkmcnt(0)
  v_pk_add_f32 v[112:113], v[112:113], v[114:115]
  v_mfma_f32_16x16x32_bf16 v[72:75], v[80:83], v[176:179], 0
  v_pk_add_f32 v[116:117], v[116:117], v[118:119]
  v_pk_add_f32 v[112:113], v[112:113], v[116:117]
  v_mfma_f32_16x16x32_bf16 v[72:75], v[84:87], v[180:183], v[72:75]
  v_add_f32 v61, v112, v113
  s_nop 0
  v_mfma_f32_16x16x32_bf16 v[72:75], v[88:91], v[240:243], v[72:75]
  v_cvt_pk_bf16_f32 v98, v64, v68
  v_cvt_pk_bf16_f32 v102, v65, v69
  v_mfma_f32_16x16x32_bf16 v[72:75], v[92:95], v[244:247], v[72:75]
  v_cvt_pk_bf16_f32 v106, v66, v70
  v_cvt_pk_bf16_f32 v110, v67, v71
  v_mfma_f32_16x16x32_bf16 v[76:79], v[80:83], v[184:187], 0
  v_xor_b32 v98, v38, v98
  v_xor_b32 v102, v38, v102
  v_mfma_f32_16x16x32_bf16 v[76:79], v[84:87], v[188:191], v[76:79]
  v_xor_b32 v106, v38, v106
  v_xor_b32 v110, v38, v110
  v_mfma_f32_16x16x32_bf16 v[76:79], v[88:91], v[248:251], v[76:79]
  v_add3_u32 v28, v96, v97, v98
  v_add3_u32 v29, v100, v101, v102
  v_mfma_f32_16x16x32_bf16 v[76:79], v[92:95], v[252:255], v[76:79]
  v_add3_u32 v30, v104, v105, v106
  v_add3_u32 v31, v108, v109, v110
  s_nop 0
  s_nop 0
  s_nop 0
  s_nop 0
  s_nop 0
  s_nop 0
  v_cvt_pk_bf16_f32 v99, v72, v76
  v_cvt_pk_bf16_f32 v103, v73, v77
  v_cvt_pk_bf16_f32 v107, v74, v78
  v_cvt_pk_bf16_f32 v111, v75, v79
  v_xor_b32 v99, v38, v99
  v_xor_b32 v103, v38, v103
  v_xor_b32 v107, v38, v107
  v_xor_b32 v111, v38, v111
  s_add_u32 s11, s13, 2097152
  buffer_store_dwordx4 v[96:99], v34, s[16:19], s11 offen sc1
  s_add_u32 s11, s13, 2228224
  buffer_store_dwordx4 v[100:103], v34, s[16:19], s11 offen sc1
  s_add_u32 s11, s13, 2359296
  buffer_store_dwordx4 v[104:107], v34, s[16:19], s11 offen sc1
  s_add_u32 s11, s13, 2490368
  buffer_store_dwordx4 v[108:111], v34, s[16:19], s11 offen sc1
  v_add_u32 v28, v28, v99
  v_add_u32 v29, v29, v103
  v_add_u32 v30, v30, v107
  v_add_u32 v31, v31, v111
  v_add_u32_dpp v28, v28, v28 row_ror:8 row_mask:0xf bank_mask:0x3
  v_add_u32_dpp v30, v30, v30 row_ror:8 row_mask:0xf bank_mask:0x3
  v_add_u32_dpp v28, v29, v29 row_ror:8 row_mask:0xf bank_mask:0xc
  v_add_u32_dpp v30, v31, v31 row_ror:8 row_mask:0xf bank_mask:0xc
  s_nop 0
  v_add_u32_dpp v28, v28, v28 row_half_mirror row_mask:0xf bank_mask:0x5
  v_add_u32_dpp v28, v30, v30 row_half_mirror row_mask:0xf bank_mask:0xa
  s_nop 1
  v_add_u32_dpp v28, v28, v28 quad_perm:[2,3,0,1] row_mask:0xf bank_mask:0xf
  v_cndmask_b32 v4, v4, v28, s[38:39]
  s_nop 1
  v_add_u32_dpp v62, v4, v4 quad_perm:[1,0,3,2] row_mask:0xf bank_mask:0xf
  s_mov_b32 exec_lo, 0x55555555
  s_mov_b32 exec_hi, 0x55555555
  buffer_store_dwordx4 v[60:63], v35, s[16:19], s14 offen sc1
  s_mov_b64 exec, -1
  buffer_store_dword v63, v39, s[16:19], s15 offen
  s_setprio 0
  s_barrier
  s_cmp_lg_u32 s3, 0
  s_cbranch_scc1 S_END
  s_and_b32 s34, s33, 7
  s_lshr_b32 s35, s33, 5
  s_lshl3_add_u32 s34, s35, s34
  s_bfe_u32 s35, s33, 0x20003
  s_lshl2_add_u32 s34, s34, s35
  s_mov_b32 s36, 4
  s_mov_b32 s4, s58
  s_mov_b32 s5, s59
  s_mov_b32 s6, 2211840
  s_mov_b32 s7, 0x20000
  s_mov_b32 s72, s50
  s_mov_b32 s73, s51
  s_mov_b32 s74, 5242880
  s_mov_b32 s75, 0x20000
  v_lshrrev_b32 v33, 4, v0
  v_and_b32 v34, 15, v0
  v_mul_u32_u24 v30, 1280, v33
  v_lshl_add_u32 v30, v34, 4, v30
  s_and_b32 s31, s31, 3
  s_lshl_b32 s39, s30, 2
  s_add_u32 s39, s39, s31
  s_lshl_b32 s14, s36, 8
  s_mul_i32 s26, s34, 20480
  s_add_u32 s26, s26, s14
  s_mul_i32 s27, s39, 40960
  s_add_u32 s27, s27, s14
  buffer_load_dwordx4 v[80:83], v30, s[72:75], s27 offen nt
  s_add_u32 s27, s27, 5120
  buffer_load_dwordx4 v[84:87], v30, s[72:75], s27 offen nt
  s_add_u32 s27, s27, 5120
  buffer_load_dwordx4 v[88:91], v30, s[72:75], s27 offen nt
  s_add_u32 s27, s27, 5120
  buffer_load_dwordx4 v[92:95], v30, s[72:75], s27 offen nt
  s_add_u32 s27, s27, 5120
  buffer_load_dwordx4 v[96:99], v30, s[72:75], s27 offen nt
  s_add_u32 s27, s27, 5120
  buffer_load_dwordx4 v[100:103], v30, s[72:75], s27 offen nt
  s_add_u32 s27, s27, 5120
  s_branch OUTB
S_END:
  s_endpgm
END:
  s_endpgm
.fill 2048, 4, 0xbf810000
.section .rodata,"a"
.p2align 6
.amdhsa_kernel gated_mix__compressed_kv_cla__geglu_ffn__decode_kernel
  .amdhsa_next_free_vgpr 256
  .amdhsa_next_free_sgpr 102
  .amdhsa_accum_offset 256
  .amdhsa_group_segment_fixed_size 0
  .amdhsa_kernarg_size 112
  .amdhsa_user_sgpr_count 2
  .amdhsa_user_sgpr_kernarg_segment_ptr 1
  .amdhsa_system_sgpr_workgroup_id_x 1
.end_amdhsa_kernel
```
